```python
import torch

def _softmax(x, axis=-1):
    return torch.softmax(x, dim=axis)
def _gelu(x):
    return torch.nn.functional.gelu(x, approximate="tanh")
def _silu(x):
    return torch.nn.functional.silu(x)
def _sigmoid(x):
    return torch.sigmoid(x)
def _layernorm(x, axis=-1, eps=1e-5):
    m = x.mean(dim=axis, keepdim=True)
    v = x.var(dim=axis, keepdim=True, unbiased=False)
    return (x - m) / torch.sqrt(v + eps)
def _scatter_add(tgt, idx, src, axis=0):
    return tgt.clone().index_add_(axis, idx, src)
def _segment_sum(src, seg, n):
    out = torch.zeros((n,) + src.shape[1:], dtype=src.dtype)
    return out.index_add_(0, seg, src)
def _pad(x, pw):
    flat = tuple(v for pair in reversed(pw) for v in pair)
    return torch.nn.functional.pad(x, flat)

kernel_name = 'parallel_sum__sliding_block__dense_activation_squared_relu__prompt'

def setup_inputs():

    _w = (lambda a: (lambda t: t.to(torch.bfloat16) if t.is_floating_point() else t)(torch.as_tensor(a)))
    def _A_setup():
        B, S, D = 1, 2048, 448
        return {
            "x": _w((lambda *s: torch.randn(*s, dtype=torch.bfloat16) * 0.05)(B, S, D)),
            "wqkv": _w((lambda *s: torch.randn(*s, dtype=torch.bfloat16) * 0.1)(D, 3 * D)),
            "wo": _w((lambda *s: torch.randn(*s, dtype=torch.bfloat16) * 0.05)(D, D)),
        }
    _A_in = _A_setup()

    def _B_setup():
        B, S, D, F = 1, 2048, 448, 1792
        return {
            "x": _w((lambda *s: torch.randn(*s, dtype=torch.bfloat16) * 0.05)(B, S, D)),
            "w1": _w((lambda *s: torch.randn(*s, dtype=torch.bfloat16) * 0.05)(D, F)),
            "b1": _w((lambda *s: torch.randn(*s, dtype=torch.bfloat16) * 0.4)(F)),
            "w2": _w((lambda *s: torch.randn(*s, dtype=torch.bfloat16) * 0.05)(F, D)),
            "b2": _w((lambda *s: torch.randn(*s, dtype=torch.bfloat16) * 1.6)(D)),
        }
    _B_in = _B_setup()

    return {
        "A_x": _A_in["x"],
        "A_wqkv": _A_in["wqkv"],
        "A_wo": _A_in["wo"],
        "B_x": _B_in["x"],
        "B_w1": _B_in["w1"],
        "B_b1": _B_in["b1"],
        "B_w2": _B_in["w2"],
        "B_b2": _B_in["b2"],
    }

def reference(A_x, A_wqkv, A_wo, B_x, B_w1, B_b1, B_w2, B_b2):
    def _A_ref(x, wqkv, wo):
        B, S, D = x.shape
        H = 16; Dh = D // H; W = 256
        qkv = (lambda x, *d: x.permute(*d))((x @ wqkv).reshape(B, S, 3, H, Dh), 2, 0, 3, 1, 4)
        q, k, v = qkv[0], qkv[1], qkv[2]
        scores = torch.einsum("bhqd,bhkd->bhqk", q, k) * (Dh ** -0.5)
        idx = torch.arange(S)
        mask = (idx[:, None] - idx[None, :] >= 0) & (idx[:, None] - idx[None, :] < W)
        scores = torch.where(mask[None, None], scores, -1e9)
        p = _softmax(scores, axis=-1)
        o = torch.einsum("bhqk,bhkd->bhqd", p, v)
        return (lambda x, *d: x.permute(*d))(o, 0, 2, 1, 3).reshape(B, S, D) @ wo

    def _B_ref(x, w1, b1, w2, b2):
        h = torch.einsum("bsd,df->bsf", x, w1) + b1
        zero = torch.zeros_like(h)
        r = torch.where(h > zero, h, zero)
        h = r * r
        out = torch.einsum("bsf,fd->bsd", h, w2) + b2
        return out

    x = A_x
    xn = _layernorm(x, axis=-1)
    return x + _A_ref(xn, A_wqkv, A_wo) + _B_ref(xn, B_w1, B_b1, B_w2, B_b2)
```

```asm
; @launch grid=(256,1,1) block=(512,1,1) lds=163840
.amdgcn_target "amdgcn-amd-amdhsa--gfx950"
.text
.globl parallel_sum__sliding_block__dense_activation_squared_relu__prompt_kernel
.p2align 8
.type parallel_sum__sliding_block__dense_activation_squared_relu__prompt_kernel,@function
parallel_sum__sliding_block__dense_activation_squared_relu__prompt_kernel:
  s_load_dwordx2 s[4:5], s[0:1], 0
  s_load_dwordx2 s[8:9], s[0:1], 8
  s_getpc_b64 s[60:61]
L_pc:
  v_lshlrev_b32 v8, 7, v0
  s_cmp_ge_u32 s2, 256
  s_cbranch_scc1 L_end
  s_cmp_lt_u32 s2, 224
  s_cbranch_scc1 L_nopf
  v_cmp_gt_u32 vcc, L_end-L_pc, v8
  s_nop 1
  s_and_saveexec_b64 s[62:63], vcc
  s_cbranch_execz L_nopf
  global_load_dword v6, v8, s[60:61]
L_nopf:
  s_mov_b64 exec, -1
  s_load_dwordx2 s[48:49], s[0:1], 16
  s_load_dwordx2 s[12:13], s[0:1], 32
  s_load_dwordx2 s[28:29], s[0:1], 40
  s_load_dwordx2 s[24:25], s[0:1], 48
  s_load_dwordx2 s[40:41], s[0:1], 56
  s_load_dwordx2 s[32:33], s[0:1], 64
  s_load_dwordx2 s[20:21], s[0:1], 72
  s_load_dwordx2 s[16:17], s[0:1], 80
  v_lshrrev_b32 v8, 6, v0
  v_and_b32 v1, 63, v0
  v_readfirstlane_b32 s52, v8
  v_and_b32 v2, 15, v0
  v_bfe_u32 v3, v0, 4, 2
  s_and_b32 s57, s2, 7
  v_lshrrev_b32 v8, 3, v1
  s_lshr_b32 s58, s2, 3
  v_and_b32 v10, 7, v1
  s_and_b32 s59, s57, 6
  v_xor_b32 v10, v10, v3
  s_and_b32 s60, s58, 3
  v_mul_u32_u24 v8, 896, v8
  s_lshl1_add_u32 s55, s59, s60
  v_lshl_add_u32 v88, v10, 4, v8
  s_lshr_b32 s61, s58, 2
  v_bfe_u32 v8, v1, 1, 3
  s_lshl1_add_u32 s60, s60, s61
  v_lshlrev_b32 v9, 1, v3
  s_and_b32 s59, s57, 1
  v_xor_b32 v8, v8, v9
  s_mul_i32 s59, s59, 7
  v_and_b32 v9, 1, v1
  s_add_u32 s56, s59, s61
  v_mul_u32_u24 v10, 2688, v3
  s_sub_u32 s59, s60, 7
  v_lshl_add_u32 v10, v9, 4, v10
  s_min_u32 s59, s59, s60
  v_lshlrev_b32 v8, 5, v8
  s_lshl_b32 s36, s59, 7
  v_xor_b32 v9, 32, v8
  s_and_b32 s53, s52, 3
  s_lshr_b32 s54, s52, 2
  s_lshl2_add_u32 s62, s55, s53
  s_mul_i32 s62, s62, 28672
  s_mul_i32 s60, s56, 192
  s_and_b32 s60, s60, 0xffffff80
  s_mul_i32 s59, s53, 43008
  s_add_u32 s60, s60, s59
  s_lshl_b32 s67, s53, 12
  s_mov_b32 s6, 0x1c0000
  s_mov_b32 s7, 0x20000
  s_mov_b32 s10, 0x126000
  s_mov_b32 s11, 0x20000
  v_add_u32 v88, s62, v88
  v_add3_u32 v90, v10, v8, s60
  v_xor_b32 v89, 64, v88
  v_add3_u32 v92, v10, v9, s60
  v_add_u32 v89, 6144, v89
  v_add_u32 v91, 9728, v90
  v_add_u32 v93, 29184, v92
  v_add_u32 v92, 19456, v92
  s_cmp_ge_u32 s58, 28
  s_waitcnt lgkmcnt(0)
  s_cbranch_scc1 L_spare
  s_cmp_eq_u32 s54, 0
  s_cbranch_scc1 L_comp
  s_setprio 2
  s_lshr_b32 s37, s53, 1
  s_lshl_b32 s37, s37, 7
  s_add_u32 s37, s37, s36
  s_add_u32 m0, s67, 0
  s_add_u32 s63, s36, 12288
  buffer_load_dwordx4 v88, s[4:7], s36 offen offset:0 lds
  buffer_load_dwordx4 v89, s[4:7], s36 offen offset:1024 lds
  s_mul_i32 s66, s36, 1344
  buffer_load_dwordx4 v88, s[4:7], s63 offen offset:2048 lds
  buffer_load_dwordx4 v89, s[4:7], s63 offen offset:3072 lds
  s_add_u32 m0, s67, 65536
  s_add_u32 s36, s36, 128
  buffer_load_dwordx4 v90, s[8:11], s66 offen offset:0 lds
  s_cmp_eq_u32 s36, 896
  s_cselect_b32 s36, 0, s36
  buffer_load_dwordx4 v91, s[8:11], s66 offen offset:1024 lds
  buffer_load_dwordx4 v92, s[8:11], s66 offen offset:2048 lds
  buffer_load_dwordx4 v93, s[8:11], s66 offen offset:3072 lds
  s_sub_u32 s59, s37, 896
  s_min_u32 s37, s37, s59
  v_lshrrev_b32 v8, 1, v2
  v_xor_b32 v8, v8, v3
  v_lshlrev_b32 v8, 4, v8
  v_lshl_add_u32 v8, v2, 7, v8
  v_add_u32 v98, s67, v8
  v_xor_b32 v99, 64, v98
  v_bfe_u32 v8, v1, 2, 2
  v_lshl_add_u32 v9, v3, 3, v8
  v_lshlrev_b32 v9, 8, v9
  v_and_b32 v10, 3, v1
  v_lshl_add_u32 v9, v10, 3, v9
  v_and_b32 v10, 1, v3
  v_lshl_or_b32 v8, v8, 1, v10
  v_lshl_or_b32 v9, v8, 5, v9
  s_and_b32 s60, s56, 1
  s_lshl1_add_u32 s60, s60, 2048
  s_add_u32 s59, s60, s53
  s_lshl_b32 s59, s59, 5
  v_xor_b32 v100, s59, v9
  s_and_b32 s61, s53, 1
  s_add_u32 s61, s61, 4
  s_add_u32 s59, s60, s61
  s_lshl_b32 s59, s59, 5
  v_xor_b32 v101, s59, v9
  v_lshlrev_b32 v108, 3, v2
  v_add_u32 v108, 147456, v108
  s_lshl_b32 s61, s61, 7
  v_add_u32 v107, s61, v108
  s_lshl_b32 s61, s53, 7
  v_add_u32 v109, s61, v108
  v_mov_b32 v116, 0x3f803f80
  v_mov_b32 v117, 0x3f803f80
  v_mov_b32 v118, 0x3f803f80
  v_mov_b32 v119, 0x3f803f80
  s_lshl_b32 s64, s52, 11
  v_lshlrev_b32 v4, 4, v1
  s_lshl_b32 s65, s52, 10
  v_bfe_u32 v32, v1, 1, 2
  s_add_u32 s44, s16, 0x1000000
  s_addc_u32 s45, s17, 0
  v_and_b32 v9, 1, v3
  s_mov_b32 s14, 0x188000
  v_xor_b32 v32, v32, v9
  s_mov_b32 s15, 0x20000
  v_lshlrev_b32 v32, 5, v32
  s_mov_b32 s50, 0x62000
  v_and_b32 v8, 1, v1
  s_mov_b32 s51, 0x20000
  v_lshl_add_u32 v32, v8, 4, v32
  s_mov_b32 s26, 0x188000
  v_lshrrev_b32 v33, 3, v1
  s_mov_b32 s27, 0x20000
  v_mul_u32_u24 v12, 896, v33
  s_mov_b32 s42, 0x380
  v_add_u32 v12, v12, v32
  s_mov_b32 s43, 0x20000
  v_xor_b32 v13, 64, v12
  s_mov_b32 s34, 0x1c0000
  v_lshlrev_b32 v8, 7, v9
  s_mov_b32 s35, 0x20000
  v_xor_b32 v21, v4, v8
  s_mov_b32 s18, 0x540000
  v_add_u32 v21, 14336, v21
  s_mov_b32 s19, 0x20000
  v_lshrrev_b32 v8, 1, v3
  s_mov_b32 s46, 0x100000
  v_mul_u32_u24 v10, 3584, v8
  s_mov_b32 s47, 0x20000
  v_sub_u32 v20, v13, v10
  s_mov_b32 s22, 0x100
  v_add_u32 v20, 2560, v20
  s_mov_b32 s23, 0x20000
  v_mul_u32_u24 v10, 10752, v8
  s_and_b32 s79, s58, 1
  v_add_u32 v18, v12, v10
  s_lshl1_add_u32 s76, s57, s79
  v_add_u32 v19, v13, v10
  s_lshr_b32 s77, s58, 1
  v_add_u32 v19, 2560, v19
  s_mul_i32 s78, s76, 7
  v_add_u32 v13, 6144, v13
  s_lshr_b32 s78, s78, 1
  v_bfe_u32 v34, v1, 2, 2
  s_lshl3_add_u32 s60, s77, s52
  v_lshlrev_b32 v34, 7, v34
  s_mul_i32 s61, s53, 6
  v_and_b32 v10, 3, v1
  s_lshl3_add_u32 s61, s77, s61
  v_lshl_add_u32 v34, v10, 3, v34
  s_sub_i32 s72, s61, 16
  v_bfe_u32 v10, v1, 3, 2
  s_lshl2_add_u32 s61, s77, s53
  v_lshl_or_b32 v34, v10, 5, v34
  s_add_u32 s59, s65, 40960
  v_lshl_add_u32 v9, v9, 10, v34
  s_add_u32 s62, s65, 16384
  v_lshl_add_u32 v9, v8, 14, v9
  v_add_u32 v14, s64, v9
  v_add_u32 v14, 81920, v14
  v_xor_b32 v15, 32, v14
  v_xor_b32 v16, 64, v14
  v_xor_b32 v17, 96, v14
  v_add_u32 v22, s59, v4
  s_sub_i32 s80, 16, s60
  v_lshrrev_b32 v8, 2, v1
  s_mul_i32 s101, s60, 168
  v_and_b32 v9, 3, v1
  s_add_u32 s101, s101, s78
  v_add_u32 v9, s79, v9
  s_lshl_b32 s101, s101, 8
  v_lshrrev_b32 v10, 1, v9
  s_mul_i32 s39, s60, 72
  v_and_b32 v23, 1, v10
  s_add_u32 s39, s39, s76
  v_lshlrev_b32 v23, 3, v23
  s_add_u32 s39, s39, 56
  v_xor_b32 v23, v23, v8
  s_lshl_b32 s39, s39, 10
  v_lshlrev_b32 v23, 4, v23
  s_add_u32 s85, s78, 56
  v_lshl_add_u32 v23, v10, 8, v23
  s_lshl_b32 s85, s85, 8
  v_and_b32 v10, 1, v9
  s_and_b32 s66, s58, 3
  v_lshl_add_u32 v23, v10, 3, v23
  s_lshl2_add_u32 s81, s57, s66
  v_add_u32 v23, s62, v23
  s_lshr_b32 s82, s58, 2
  v_bfe_u32 v8, v1, 1, 2
  s_min_u32 s82, s82, 6
  v_min_u32 v8, 2, v8
  s_lshl_b32 s66, s82, 7
  v_lshl_add_u32 v8, v8, 1, s72
  s_mul_i32 s83, s52, 200704
  v_max_i32 v8, 0, v8
  s_add_u32 s83, s83, s66
  v_lshrrev_b32 v8, 1, v8
  s_mul_i32 s84, s52, 50176
  v_min_u32 v9, 2, v3
  s_add_u32 s84, s84, s66
  v_mov_b32 v10, s61
  s_lshl1_add_u32 s66, s77, s54
  v_cmp_eq_u32 vcc, 0, v9
  s_lshl4_add_u32 s66, s66, s76
  v_mul_u32_u24 v9, 56, v9
  s_lshl2_add_u32 s66, s66, s53
  v_cndmask_b32 v8, v8, v10, vcc
  s_lshl3_add_u32 s75, s66, 524288
  v_and_b32 v10, 1, v1
  v_mul_u32_u24 v10, 3, v10
  v_add3_u32 v9, v9, v10, s78
  v_mul_u32_u24 v9, 171, v9
  v_lshrrev_b32 v9, 11, v9
  v_lshl_add_u32 v8, v8, 4, v9
  v_lshlrev_b32 v5, 6, v8
  s_lshl_b32 s68, s53, 11
  s_sub_u32 s71, s83, 802816
  v_mul_u32_u24 v94, 3584, v33
  s_and_b32 s59, s53, 1
  s_mul_i32 s59, s59, 114688
  s_lshl_b32 s60, s56, 8
  s_add_u32 s59, s59, s60
  v_and_b32 v9, 1, v3
  v_mul_u32_u24 v9, 96, v9
  v_xor_b32 v9, v9, v32
  v_add3_u32 v94, v94, v9, s59
  v_xor_b32 v95, 32, v94
  v_add_u32 v96, 55296, v94
  v_add_u32 v97, 82944, v95
  v_add_u32 v95, 27648, v95
  v_lshrrev_b32 v9, 3, v1
  v_xor_b32 v9, v9, v3
  v_and_b32 v9, 1, v9
  v_mul_u32_u24 v9, 96, v9
  v_xor_b32 v9, v9, v34
  v_lshl_add_u32 v28, v3, 10, v9
  s_lshl_b32 s59, s53, 5
  v_xor_b32 v28, s59, v28
  v_add_u32 v29, 81920, v28
  s_lshl_b32 s59, s53, 9
  s_add_u32 s59, s59, 149504
  v_lshl_add_u32 v103, v2, 4, s59
  v_add_u32 v9, 151552, v4
  v_lshrrev_b32 v10, 2, v2
  v_cmp_eq_u32 vcc, v10, v3
  s_nop 1
  v_cndmask_b32 v104, v9, v103, vcc
  v_mov_b32 v112, 0
  v_mov_b32 v113, 0
  v_lshlrev_b32 v111, 1, v2
  s_lshl3_add_u32 s59, s56, s53
  s_lshl_b32 s59, s59, 5
  s_mov_b32 s30, 0xe00
  s_mov_b32 s31, 0x20000
  s_add_u32 m0, s67, 16384
  s_add_u32 s63, s36, 12288
  buffer_load_dwordx4 v88, s[4:7], s36 offen offset:0 lds
  buffer_load_dwordx4 v89, s[4:7], s36 offen offset:1024 lds
  s_mul_i32 s66, s36, 1344
  buffer_load_dwordx4 v88, s[4:7], s63 offen offset:2048 lds
  buffer_load_dwordx4 v89, s[4:7], s63 offen offset:3072 lds
  s_add_u32 m0, s67, 81920
  s_add_u32 s36, s36, 128
  buffer_load_dwordx4 v90, s[8:11], s66 offen offset:0 lds
  s_cmp_eq_u32 s36, 896
  s_cselect_b32 s36, 0, s36
  buffer_load_dwordx4 v91, s[8:11], s66 offen offset:1024 lds
  buffer_load_dwordx4 v92, s[8:11], s66 offen offset:2048 lds
  buffer_load_dwordx4 v93, s[8:11], s66 offen offset:3072 lds
  buffer_load_short_d16_hi v112, v111, s[28:31], s59 offen
  buffer_load_short_d16_hi v113, v111, s[28:31], s59 offen offset:128
  s_add_u32 s28, s16, 0x600000
  s_addc_u32 s29, s17, 0
  s_mov_b32 s30, 0x900000
  s_mov_b32 s31, 0x20000
  s_waitcnt vmcnt(10)
  s_barrier
  s_add_u32 m0, s67, 32768
  s_add_u32 s63, s36, 12288
  buffer_load_dwordx4 v88, s[4:7], s36 offen offset:0 lds
  ds_read_b128 v[32:35], v98 offset:0
  ds_read_b128 v[36:39], v98 offset:2048
  ds_read_b64_tr_b16 v[40:41], v100 offset:0
  ds_read_b64_tr_b16 v[42:43], v100 offset:1024
  ds_read_b64_tr_b16 v[44:45], v101 offset:0
  ds_read_b64_tr_b16 v[46:47], v101 offset:1024
  buffer_load_dwordx4 v89, s[4:7], s36 offen offset:1024 lds
  s_mul_i32 s66, s36, 1344
  ds_read_b128 v[48:51], v99 offset:0
  ds_read_b128 v[52:55], v99 offset:2048
  ds_read_b64_tr_b16 v[56:57], v100 offset:8192
  ds_read_b64_tr_b16 v[58:59], v100 offset:9216
  ds_read_b64_tr_b16 v[60:61], v101 offset:8192
  ds_read_b64_tr_b16 v[62:63], v101 offset:9216
  buffer_load_dwordx4 v88, s[4:7], s63 offen offset:2048 lds
  s_waitcnt lgkmcnt(6)
  buffer_load_dwordx4 v89, s[4:7], s63 offen offset:3072 lds
  s_add_u32 m0, s67, 98304
  s_add_u32 s36, s36, 128
  v_mfma_f32_16x16x32_bf16 v[64:67], v[32:35], v[32:35], 0
  v_mfma_f32_16x16x32_bf16 v[68:71], v[36:39], v[36:39], 0
  buffer_load_dwordx4 v90, s[8:11], s66 offen offset:0 lds
  s_cmp_eq_u32 s36, 896
  s_cselect_b32 s36, 0, s36
  v_mfma_f32_16x16x32_bf16 v[72:75], v[116:119], v[32:35], 0
  v_mfma_f32_16x16x32_bf16 v[76:79], v[116:119], v[36:39], 0
  v_mfma_f32_16x16x32_bf16 v[80:83], v[116:119], v[40:43], 0
  buffer_load_dwordx4 v91, s[8:11], s66 offen offset:1024 lds
  v_mfma_f32_16x16x32_bf16 v[84:87], v[116:119], v[44:47], 0
  s_waitcnt lgkmcnt(0)
  v_mfma_f32_16x16x32_bf16 v[64:67], v[48:51], v[48:51], v[64:67]
  buffer_load_dwordx4 v92, s[8:11], s66 offen offset:2048 lds
  v_mfma_f32_16x16x32_bf16 v[68:71], v[52:55], v[52:55], v[68:71]
  v_mfma_f32_16x16x32_bf16 v[72:75], v[116:119], v[48:51], v[72:75]
  v_mfma_f32_16x16x32_bf16 v[76:79], v[116:119], v[52:55], v[76:79]
  buffer_load_dwordx4 v93, s[8:11], s66 offen offset:3072 lds
  v_mfma_f32_16x16x32_bf16 v[80:83], v[116:119], v[56:59], v[80:83]
  v_mfma_f32_16x16x32_bf16 v[84:87], v[116:119], v[60:63], v[84:87]
  s_waitcnt vmcnt(10)
  s_barrier
  s_cmp_lg_u32 s53, 0
  s_cbranch_scc1 L_tg1
  buffer_load_dwordx2 v[6:7], off, s[20:23], 0 sc1
L_tg1:
  s_add_u32 m0, s67, 0
  s_add_u32 s63, s36, 12288
  buffer_load_dwordx4 v88, s[4:7], s36 offen offset:0 lds
  ds_read_b128 v[32:35], v98 offset:16384
  ds_read_b128 v[36:39], v98 offset:18432
  ds_read_b64_tr_b16 v[40:41], v100 offset:16384
  ds_read_b64_tr_b16 v[42:43], v100 offset:17408
  ds_read_b64_tr_b16 v[44:45], v101 offset:16384
  ds_read_b64_tr_b16 v[46:47], v101 offset:17408
  buffer_load_dwordx4 v89, s[4:7], s36 offen offset:1024 lds
  s_mul_i32 s66, s36, 1344
  ds_read_b128 v[48:51], v99 offset:16384
  ds_read_b128 v[52:55], v99 offset:18432
  ds_read_b64_tr_b16 v[56:57], v100 offset:24576
  ds_read_b64_tr_b16 v[58:59], v100 offset:25600
  ds_read_b64_tr_b16 v[60:61], v101 offset:24576
  ds_read_b64_tr_b16 v[62:63], v101 offset:25600
  buffer_load_dwordx4 v88, s[4:7], s63 offen offset:2048 lds
  s_waitcnt lgkmcnt(6)
  buffer_load_dwordx4 v89, s[4:7], s63 offen offset:3072 lds
  s_add_u32 m0, s67, 65536
  s_add_u32 s36, s36, 128
  v_mfma_f32_16x16x32_bf16 v[64:67], v[32:35], v[32:35], v[64:67]
  v_mfma_f32_16x16x32_bf16 v[68:71], v[36:39], v[36:39], v[68:71]
  buffer_load_dwordx4 v90, s[8:11], s66 offen offset:0 lds
  s_cmp_eq_u32 s36, 896
  s_cselect_b32 s36, 0, s36
  v_mfma_f32_16x16x32_bf16 v[72:75], v[116:119], v[32:35], v[72:75]
  v_mfma_f32_16x16x32_bf16 v[76:79], v[116:119], v[36:39], v[76:79]
  v_mfma_f32_16x16x32_bf16 v[80:83], v[116:119], v[40:43], v[80:83]
  buffer_load_dwordx4 v91, s[8:11], s66 offen offset:1024 lds
  v_mfma_f32_16x16x32_bf16 v[84:87], v[116:119], v[44:47], v[84:87]
  s_waitcnt lgkmcnt(0)
  v_mfma_f32_16x16x32_bf16 v[64:67], v[48:51], v[48:51], v[64:67]
  buffer_load_dwordx4 v92, s[8:11], s66 offen offset:2048 lds
  v_mfma_f32_16x16x32_bf16 v[68:71], v[52:55], v[52:55], v[68:71]
  v_mfma_f32_16x16x32_bf16 v[72:75], v[116:119], v[48:51], v[72:75]
  v_mfma_f32_16x16x32_bf16 v[76:79], v[116:119], v[52:55], v[76:79]
  buffer_load_dwordx4 v93, s[8:11], s66 offen offset:3072 lds
  v_mfma_f32_16x16x32_bf16 v[80:83], v[116:119], v[56:59], v[80:83]
  v_mfma_f32_16x16x32_bf16 v[84:87], v[116:119], v[60:63], v[84:87]
  s_waitcnt vmcnt(8)
  s_barrier
  s_add_u32 m0, s67, 16384
  s_add_u32 s63, s36, 12288
  buffer_load_dwordx4 v88, s[4:7], s36 offen offset:0 lds
  ds_read_b128 v[32:35], v98 offset:32768
  ds_read_b128 v[36:39], v98 offset:34816
  ds_read_b64_tr_b16 v[40:41], v100 offset:32768
  ds_read_b64_tr_b16 v[42:43], v100 offset:33792
  ds_read_b64_tr_b16 v[44:45], v101 offset:32768
  ds_read_b64_tr_b16 v[46:47], v101 offset:33792
  buffer_load_dwordx4 v89, s[4:7], s36 offen offset:1024 lds
  s_mul_i32 s66, s36, 1344
  ds_read_b128 v[48:51], v99 offset:32768
  ds_read_b128 v[52:55], v99 offset:34816
  ds_read_b64_tr_b16 v[56:57], v100 offset:40960
  ds_read_b64_tr_b16 v[58:59], v100 offset:41984
  ds_read_b64_tr_b16 v[60:61], v101 offset:40960
  ds_read_b64_tr_b16 v[62:63], v101 offset:41984
  buffer_load_dwordx4 v88, s[4:7], s63 offen offset:2048 lds
  s_waitcnt lgkmcnt(6)
  buffer_load_dwordx4 v89, s[4:7], s63 offen offset:3072 lds
  s_add_u32 m0, s67, 81920
  s_add_u32 s36, s36, 128
  v_mfma_f32_16x16x32_bf16 v[64:67], v[32:35], v[32:35], v[64:67]
  v_mfma_f32_16x16x32_bf16 v[68:71], v[36:39], v[36:39], v[68:71]
  buffer_load_dwordx4 v90, s[8:11], s66 offen offset:0 lds
  s_cmp_eq_u32 s36, 896
  s_cselect_b32 s36, 0, s36
  v_mfma_f32_16x16x32_bf16 v[72:75], v[116:119], v[32:35], v[72:75]
  v_mfma_f32_16x16x32_bf16 v[76:79], v[116:119], v[36:39], v[76:79]
  v_mfma_f32_16x16x32_bf16 v[80:83], v[116:119], v[40:43], v[80:83]
  buffer_load_dwordx4 v91, s[8:11], s66 offen offset:1024 lds
  v_mfma_f32_16x16x32_bf16 v[84:87], v[116:119], v[44:47], v[84:87]
  s_waitcnt lgkmcnt(0)
  v_mfma_f32_16x16x32_bf16 v[64:67], v[48:51], v[48:51], v[64:67]
  buffer_load_dwordx4 v92, s[8:11], s66 offen offset:2048 lds
  v_mfma_f32_16x16x32_bf16 v[68:71], v[52:55], v[52:55], v[68:71]
  v_mfma_f32_16x16x32_bf16 v[72:75], v[116:119], v[48:51], v[72:75]
  v_mfma_f32_16x16x32_bf16 v[76:79], v[116:119], v[52:55], v[76:79]
  buffer_load_dwordx4 v93, s[8:11], s66 offen offset:3072 lds
  v_mfma_f32_16x16x32_bf16 v[80:83], v[116:119], v[56:59], v[80:83]
  v_mfma_f32_16x16x32_bf16 v[84:87], v[116:119], v[60:63], v[84:87]
  s_waitcnt vmcnt(8)
  s_barrier
  s_add_u32 m0, s67, 32768
  s_add_u32 s63, s36, 12288
  buffer_load_dwordx4 v88, s[4:7], s36 offen offset:0 lds
  ds_read_b128 v[32:35], v98 offset:0
  ds_read_b128 v[36:39], v98 offset:2048
  ds_read_b64_tr_b16 v[40:41], v100 offset:0
  ds_read_b64_tr_b16 v[42:43], v100 offset:1024
  ds_read_b64_tr_b16 v[44:45], v101 offset:0
  ds_read_b64_tr_b16 v[46:47], v101 offset:1024
  buffer_load_dwordx4 v89, s[4:7], s36 offen offset:1024 lds
  s_mul_i32 s66, s36, 1344
  ds_read_b128 v[48:51], v99 offset:0
  ds_read_b128 v[52:55], v99 offset:2048
  ds_read_b64_tr_b16 v[56:57], v100 offset:8192
  ds_read_b64_tr_b16 v[58:59], v100 offset:9216
  ds_read_b64_tr_b16 v[60:61], v101 offset:8192
  ds_read_b64_tr_b16 v[62:63], v101 offset:9216
  buffer_load_dwordx4 v88, s[4:7], s63 offen offset:2048 lds
  s_waitcnt lgkmcnt(6)
  buffer_load_dwordx4 v89, s[4:7], s63 offen offset:3072 lds
  s_add_u32 m0, s67, 98304
  s_add_u32 s36, s36, 128
  v_mfma_f32_16x16x32_bf16 v[64:67], v[32:35], v[32:35], v[64:67]
  v_mfma_f32_16x16x32_bf16 v[68:71], v[36:39], v[36:39], v[68:71]
  buffer_load_dwordx4 v90, s[8:11], s66 offen offset:0 lds
  s_cmp_eq_u32 s36, 896
  s_cselect_b32 s36, 0, s36
  v_mfma_f32_16x16x32_bf16 v[72:75], v[116:119], v[32:35], v[72:75]
  v_mfma_f32_16x16x32_bf16 v[76:79], v[116:119], v[36:39], v[76:79]
  v_mfma_f32_16x16x32_bf16 v[80:83], v[116:119], v[40:43], v[80:83]
  buffer_load_dwordx4 v91, s[8:11], s66 offen offset:1024 lds
  v_mfma_f32_16x16x32_bf16 v[84:87], v[116:119], v[44:47], v[84:87]
  s_waitcnt lgkmcnt(0)
  v_mfma_f32_16x16x32_bf16 v[64:67], v[48:51], v[48:51], v[64:67]
  buffer_load_dwordx4 v92, s[8:11], s66 offen offset:2048 lds
  v_mfma_f32_16x16x32_bf16 v[68:71], v[52:55], v[52:55], v[68:71]
  v_mfma_f32_16x16x32_bf16 v[72:75], v[116:119], v[48:51], v[72:75]
  v_mfma_f32_16x16x32_bf16 v[76:79], v[116:119], v[52:55], v[76:79]
  buffer_load_dwordx4 v93, s[8:11], s66 offen offset:3072 lds
  v_mfma_f32_16x16x32_bf16 v[80:83], v[116:119], v[56:59], v[80:83]
  v_mfma_f32_16x16x32_bf16 v[84:87], v[116:119], v[60:63], v[84:87]
  s_waitcnt vmcnt(8)
  s_barrier
  s_add_u32 m0, s67, 0
  s_add_u32 s63, s36, 12288
  buffer_load_dwordx4 v88, s[4:7], s36 offen offset:0 lds
  ds_read_b128 v[32:35], v98 offset:16384
  ds_read_b128 v[36:39], v98 offset:18432
  ds_read_b64_tr_b16 v[40:41], v100 offset:16384
  ds_read_b64_tr_b16 v[42:43], v100 offset:17408
  ds_read_b64_tr_b16 v[44:45], v101 offset:16384
  ds_read_b64_tr_b16 v[46:47], v101 offset:17408
  buffer_load_dwordx4 v89, s[4:7], s36 offen offset:1024 lds
  s_mul_i32 s66, s36, 1344
  ds_read_b128 v[48:51], v99 offset:16384
  ds_read_b128 v[52:55], v99 offset:18432
  ds_read_b64_tr_b16 v[56:57], v100 offset:24576
  ds_read_b64_tr_b16 v[58:59], v100 offset:25600
  ds_read_b64_tr_b16 v[60:61], v101 offset:24576
  ds_read_b64_tr_b16 v[62:63], v101 offset:25600
  buffer_load_dwordx4 v88, s[4:7], s63 offen offset:2048 lds
  s_waitcnt lgkmcnt(6)
  buffer_load_dwordx4 v89, s[4:7], s63 offen offset:3072 lds
  s_add_u32 m0, s67, 65536
  s_add_u32 s36, s36, 128
  v_mfma_f32_16x16x32_bf16 v[64:67], v[32:35], v[32:35], v[64:67]
  v_mfma_f32_16x16x32_bf16 v[68:71], v[36:39], v[36:39], v[68:71]
  buffer_load_dwordx4 v90, s[8:11], s66 offen offset:0 lds
  s_cmp_eq_u32 s36, 896
  s_cselect_b32 s36, 0, s36
  v_mfma_f32_16x16x32_bf16 v[72:75], v[116:119], v[32:35], v[72:75]
  v_mfma_f32_16x16x32_bf16 v[76:79], v[116:119], v[36:39], v[76:79]
  v_mfma_f32_16x16x32_bf16 v[80:83], v[116:119], v[40:43], v[80:83]
  buffer_load_dwordx4 v91, s[8:11], s66 offen offset:1024 lds
  v_mfma_f32_16x16x32_bf16 v[84:87], v[116:119], v[44:47], v[84:87]
  s_waitcnt lgkmcnt(0)
  v_mfma_f32_16x16x32_bf16 v[64:67], v[48:51], v[48:51], v[64:67]
  buffer_load_dwordx4 v92, s[8:11], s66 offen offset:2048 lds
  v_mfma_f32_16x16x32_bf16 v[68:71], v[52:55], v[52:55], v[68:71]
  v_mfma_f32_16x16x32_bf16 v[72:75], v[116:119], v[48:51], v[72:75]
  v_mfma_f32_16x16x32_bf16 v[76:79], v[116:119], v[52:55], v[76:79]
  buffer_load_dwordx4 v93, s[8:11], s66 offen offset:3072 lds
  v_mfma_f32_16x16x32_bf16 v[80:83], v[116:119], v[56:59], v[80:83]
  v_mfma_f32_16x16x32_bf16 v[84:87], v[116:119], v[60:63], v[84:87]
  s_cmp_lg_u32 s53, 0
  s_cbranch_scc1 L_tg2
  v_cmp_eq_u32 vcc, 0, v6
  s_mov_b32 s63, 0
  s_nop 0
  s_cmp_eq_u64 vcc, 0
  s_cbranch_scc1 Lok_2
Lpoll_1:
  buffer_load_dwordx2 v[6:7], off, s[20:23], 0 sc1
  s_waitcnt vmcnt(0)
  v_cmp_eq_u32 vcc, 0, v6
  s_add_u32 s63, s63, 1
  s_nop 0
  s_cmp_eq_u64 vcc, 0
  s_cbranch_scc1 Lok_2
  s_cmp_lt_u32 s63, 100000
  s_sleep 4
  s_cbranch_scc1 Lpoll_1
Lok_2:
  v_mov_b32 v8, 153600
  ds_write_b64 v8, v[6:7]
  s_waitcnt lgkmcnt(0)
L_tg2:
  s_waitcnt vmcnt(8)
  s_barrier
  s_add_u32 m0, s67, 49152
  s_mul_i32 s66, s37, 1792
  buffer_load_dwordx4 v94, s[12:15], s66 offen offset:0 lds
  ds_read_b128 v[32:35], v98 offset:32768
  ds_read_b128 v[36:39], v98 offset:34816
  ds_read_b64_tr_b16 v[40:41], v100 offset:32768
  ds_read_b64_tr_b16 v[42:43], v100 offset:33792
  ds_read_b64_tr_b16 v[44:45], v101 offset:32768
  ds_read_b64_tr_b16 v[46:47], v101 offset:33792
  buffer_load_dwordx4 v95, s[12:15], s66 offen offset:1024 lds
  s_add_u32 s37, s37, 256
  s_sub_u32 s63, s37, 896
  s_min_u32 s37, s37, s63
  ds_read_b128 v[48:51], v99 offset:32768
  ds_read_b128 v[52:55], v99 offset:34816
  ds_read_b64_tr_b16 v[56:57], v100 offset:40960
  ds_read_b64_tr_b16 v[58:59], v100 offset:41984
  ds_read_b64_tr_b16 v[60:61], v101 offset:40960
  ds_read_b64_tr_b16 v[62:63], v101 offset:41984
  buffer_load_dwordx4 v96, s[12:15], s66 offen offset:2048 lds
  s_waitcnt lgkmcnt(6)
  buffer_load_dwordx4 v97, s[12:15], s66 offen offset:3072 lds
  v_mfma_f32_16x16x32_bf16 v[64:67], v[32:35], v[32:35], v[64:67]
  v_mfma_f32_16x16x32_bf16 v[68:71], v[36:39], v[36:39], v[68:71]
  s_add_u32 m0, s67, 114688
  s_mul_i32 s66, s37, 1792
  buffer_load_dwordx4 v94, s[12:15], s66 offen offset:0 lds
  v_mfma_f32_16x16x32_bf16 v[72:75], v[116:119], v[32:35], v[72:75]
  v_mfma_f32_16x16x32_bf16 v[76:79], v[116:119], v[36:39], v[76:79]
  v_mfma_f32_16x16x32_bf16 v[80:83], v[116:119], v[40:43], v[80:83]
  buffer_load_dwordx4 v95, s[12:15], s66 offen offset:1024 lds
  s_add_u32 s37, s37, 256
  s_sub_u32 s63, s37, 896
  s_min_u32 s37, s37, s63
  v_mfma_f32_16x16x32_bf16 v[84:87], v[116:119], v[44:47], v[84:87]
  s_waitcnt lgkmcnt(0)
  v_mfma_f32_16x16x32_bf16 v[64:67], v[48:51], v[48:51], v[64:67]
  buffer_load_dwordx4 v96, s[12:15], s66 offen offset:2048 lds
  v_mfma_f32_16x16x32_bf16 v[68:71], v[52:55], v[52:55], v[68:71]
  v_mfma_f32_16x16x32_bf16 v[72:75], v[116:119], v[48:51], v[72:75]
  v_mfma_f32_16x16x32_bf16 v[76:79], v[116:119], v[52:55], v[76:79]
  buffer_load_dwordx4 v97, s[12:15], s66 offen offset:3072 lds
  v_mfma_f32_16x16x32_bf16 v[80:83], v[116:119], v[56:59], v[80:83]
  v_mfma_f32_16x16x32_bf16 v[84:87], v[116:119], v[60:63], v[84:87]
  v_mov_b32 v10, 153600
  ds_read_b64 v[6:7], v10
  s_waitcnt vmcnt(8) lgkmcnt(0)
  s_barrier
  s_add_u32 m0, s67, 131072
  s_mul_i32 s66, s37, 1792
  buffer_load_dwordx4 v94, s[12:15], s66 offen offset:0 lds
  ds_read_b128 v[32:35], v98 offset:0
  ds_read_b128 v[36:39], v98 offset:2048
  ds_read_b64_tr_b16 v[40:41], v100 offset:0
  ds_read_b64_tr_b16 v[42:43], v100 offset:1024
  ds_read_b64_tr_b16 v[44:45], v101 offset:0
  ds_read_b64_tr_b16 v[46:47], v101 offset:1024
  buffer_load_dwordx4 v95, s[12:15], s66 offen offset:1024 lds
  s_add_u32 s37, s37, 256
  s_sub_u32 s63, s37, 896
  s_min_u32 s37, s37, s63
  ds_read_b128 v[48:51], v99 offset:0
  ds_read_b128 v[52:55], v99 offset:2048
  ds_read_b64_tr_b16 v[56:57], v100 offset:8192
  ds_read_b64_tr_b16 v[58:59], v100 offset:9216
  ds_read_b64_tr_b16 v[60:61], v101 offset:8192
  ds_read_b64_tr_b16 v[62:63], v101 offset:9216
  buffer_load_dwordx4 v96, s[12:15], s66 offen offset:2048 lds
  s_waitcnt lgkmcnt(6)
  buffer_load_dwordx4 v97, s[12:15], s66 offen offset:3072 lds
  v_mfma_f32_16x16x32_bf16 v[64:67], v[32:35], v[32:35], v[64:67]
  v_mfma_f32_16x16x32_bf16 v[68:71], v[36:39], v[36:39], v[68:71]
  s_add_u32 m0, s67, 16384
  s_mul_i32 s66, s37, 1792
  s_lshr_b32 s63, s53, 1
  s_lshl_b32 s63, s63, 7
  s_add_u32 s66, s66, s63
  buffer_load_dwordx4 v94, s[12:15], s66 offen offset:0 lds
  v_mfma_f32_16x16x32_bf16 v[72:75], v[116:119], v[32:35], v[72:75]
  v_mfma_f32_16x16x32_bf16 v[76:79], v[116:119], v[36:39], v[76:79]
  v_mfma_f32_16x16x32_bf16 v[80:83], v[116:119], v[40:43], v[80:83]
  buffer_load_dwordx4 v95, s[12:15], s66 offen offset:1024 lds
  s_add_u32 s37, s37, 256
  s_sub_u32 s63, s37, 896
  s_min_u32 s37, s37, s63
  v_mfma_f32_16x16x32_bf16 v[84:87], v[116:119], v[44:47], v[84:87]
  s_waitcnt lgkmcnt(0)
  v_mfma_f32_16x16x32_bf16 v[64:67], v[48:51], v[48:51], v[64:67]
  buffer_load_dwordx4 v96, s[12:15], s66 offen offset:2048 lds
  v_mfma_f32_16x16x32_bf16 v[68:71], v[52:55], v[52:55], v[68:71]
  v_mfma_f32_16x16x32_bf16 v[72:75], v[116:119], v[48:51], v[72:75]
  v_mfma_f32_16x16x32_bf16 v[76:79], v[116:119], v[52:55], v[76:79]
  buffer_load_dwordx4 v97, s[12:15], s66 offen offset:3072 lds
  v_mfma_f32_16x16x32_bf16 v[80:83], v[116:119], v[56:59], v[80:83]
  v_mfma_f32_16x16x32_bf16 v[84:87], v[116:119], v[60:63], v[84:87]
  s_waitcnt vmcnt(12)
  s_barrier
  ds_read_b64_tr_b16 v[32:33], v28 offset:49152
  ds_read_b64_tr_b16 v[34:35], v28 offset:49664
  ds_read_b64_tr_b16 v[36:37], v28 offset:53248
  ds_read_b64_tr_b16 v[38:39], v28 offset:53760
  ds_read_b64_tr_b16 v[40:41], v28 offset:57344
  ds_read_b64_tr_b16 v[42:43], v28 offset:57856
  ds_read_b64_tr_b16 v[44:45], v28 offset:61440
  ds_read_b64_tr_b16 v[46:47], v28 offset:61952
  v_and_b32 v9, 1, v2
  v_cmp_eq_u32 s[60:61], 1, v9
  v_and_b32 v9, 2, v2
  v_cmp_eq_u32 vcc, 2, v9
  v_and_b32 v81, 0xffff0000, v80
  s_add_u32 m0, s67, 32768
  s_mul_i32 s66, s37, 1792
  s_add_u32 s66, s66, 128
  buffer_load_dwordx4 v94, s[12:15], s66 offen offset:0 lds
  v_and_b32 v85, 0xffff0000, v84
  v_sub_f32 v82, v80, v81
  v_sub_f32 v86, v84, v85
  v_and_b32 v83, 0xffff0000, v82
  v_and_b32 v87, 0xffff0000, v86
  v_lshrrev_b32 v81, 16, v81
  v_lshrrev_b32 v85, 16, v85
  v_sub_f32 v82, v82, v83
  v_sub_f32 v86, v86, v87
  v_or_b32 v80, v81, v83
  v_or_b32 v84, v85, v87
  v_lshrrev_b32 v81, 16, v82
  v_lshrrev_b32 v85, 16, v86
  ds_write_b64 v109, v[80:81] offset:1024
  buffer_load_dwordx4 v95, s[12:15], s66 offen offset:1024 lds
  s_add_u32 s37, s37, 256
  s_sub_u32 s63, s37, 896
  s_min_u32 s37, s37, s63
  ds_write_b64 v107, v[84:85] offset:1024
  v_cndmask_b32 v64, v64, v65, s[60:61]
  v_cndmask_b32 v68, v68, v69, s[60:61]
  v_cndmask_b32 v66, v66, v67, s[60:61]
  v_cndmask_b32 v70, v70, v71, s[60:61]
  v_mul_f32 v72, 0x3b124925, v72
  v_mul_f32 v76, 0x3b124925, v76
  v_cndmask_b32 v64, v64, v66, vcc
  v_cndmask_b32 v68, v68, v70, vcc
  v_mul_f32 v64, 0x3b124925, v64
  v_mul_f32 v68, 0x3b124925, v68
  v_fma_f32 v64, -v72, v72, v64
  v_fma_f32 v68, -v76, v76, v68
  v_max_f32 v64, 0, v64
  v_max_f32 v68, 0, v68
  buffer_load_dwordx4 v96, s[12:15], s66 offen offset:2048 lds
  v_cvt_pk_bf16_f32 v64, v64, v64
  v_cvt_pk_bf16_f32 v68, v68, v68
  v_lshlrev_b32 v64, 16, v64
  v_lshlrev_b32 v68, 16, v68
  v_add_f32 v64, 0x3727c5ac, v64
  v_add_f32 v68, 0x3727c5ac, v68
  v_cvt_pk_bf16_f32 v64, v64, v64
  v_cvt_pk_bf16_f32 v68, v68, v68
  v_lshlrev_b32 v64, 16, v64
  v_lshlrev_b32 v68, 16, v68
  v_sqrt_f32 v64, v64
  v_sqrt_f32 v68, v68
  v_sub_f32 v72, 0, v72
  v_sub_f32 v76, 0, v76
  buffer_load_dwordx4 v97, s[12:15], s66 offen offset:3072 lds
  v_cvt_pk_bf16_f32 v73, v72, v64
  v_cvt_pk_bf16_f32 v77, v76, v68
  v_cvt_pk_bf16_f32 v72, v72, v72
  v_cvt_pk_bf16_f32 v76, v76, v76
  v_and_b32 v64, 0xffff0000, v73
  v_and_b32 v68, 0xffff0000, v77
  v_rcp_f32 v74, v64
  v_rcp_f32 v78, v68
  s_nop 0
  s_nop 0
  v_mul_f32 v75, v74, v74
  v_mul_f32 v79, v78, v78
  ds_write_b128 v104, v[72:75] offset:0
  ds_write_b128 v104, v[76:79] offset:256
  s_waitcnt lgkmcnt(4)
  v_mfma_f32_16x16x32_bf16 v[120:123], v[116:119], v[32:35], 0
  v_mfma_f32_16x16x32_bf16 v[120:123], v[116:119], v[36:39], v[120:123]
  v_mfma_f32_16x16x32_bf16 v[120:123], v[116:119], v[40:43], v[120:123]
  v_mfma_f32_16x16x32_bf16 v[120:123], v[116:119], v[44:47], v[120:123]
  s_waitcnt vmcnt(12) lgkmcnt(0)
  s_barrier
  ds_read_b64_tr_b16 v[32:33], v29 offset:32768
  ds_read_b64_tr_b16 v[34:35], v29 offset:33280
  ds_read_b64_tr_b16 v[36:37], v29 offset:36864
  ds_read_b64_tr_b16 v[38:39], v29 offset:37376
  ds_read_b64_tr_b16 v[40:41], v29 offset:40960
  ds_read_b64_tr_b16 v[42:43], v29 offset:41472
  ds_read_b64_tr_b16 v[44:45], v29 offset:45056
  ds_read_b64_tr_b16 v[46:47], v29 offset:45568
  s_add_u32 m0, s67, 0
  s_mul_i32 s66, s37, 1792
  s_add_u32 s66, s66, 128
  buffer_load_dwordx4 v94, s[12:15], s66 offen offset:0 lds
  buffer_load_dwordx4 v95, s[12:15], s66 offen offset:1024 lds
  s_add_u32 s37, s37, 256
  s_sub_u32 s63, s37, 896
  s_min_u32 s37, s37, s63
  s_waitcnt lgkmcnt(0)
  v_mfma_f32_16x16x32_bf16 v[120:123], v[116:119], v[32:35], v[120:123]
  v_mfma_f32_16x16x32_bf16 v[120:123], v[116:119], v[36:39], v[120:123]
  v_mfma_f32_16x16x32_bf16 v[120:123], v[116:119], v[40:43], v[120:123]
  v_mfma_f32_16x16x32_bf16 v[120:123], v[116:119], v[44:47], v[120:123]
  buffer_load_dwordx4 v96, s[12:15], s66 offen offset:2048 lds
  buffer_load_dwordx4 v97, s[12:15], s66 offen offset:3072 lds
  s_add_u32 m0, s67, 65536
  s_mul_i32 s66, s37, 1792
  s_add_u32 s66, s66, 128
  buffer_load_dwordx4 v94, s[12:15], s66 offen offset:0 lds
  buffer_load_dwordx4 v95, s[12:15], s66 offen offset:1024 lds
  s_add_u32 s37, s37, 256
  s_sub_u32 s63, s37, 896
  s_min_u32 s37, s37, s63
  buffer_load_dwordx4 v96, s[12:15], s66 offen offset:2048 lds
  buffer_load_dwordx4 v97, s[12:15], s66 offen offset:3072 lds
  s_waitcnt vmcnt(16)
  s_barrier
  ds_read_b64_tr_b16 v[32:33], v29 offset:49152
  ds_read_b64_tr_b16 v[34:35], v29 offset:49664
  ds_read_b64_tr_b16 v[36:37], v29 offset:53248
  ds_read_b64_tr_b16 v[38:39], v29 offset:53760
  ds_read_b64_tr_b16 v[40:41], v29 offset:57344
  ds_read_b64_tr_b16 v[42:43], v29 offset:57856
  ds_read_b64_tr_b16 v[44:45], v29 offset:61440
  ds_read_b64_tr_b16 v[46:47], v29 offset:61952
  s_add_u32 m0, s68, 81920
  s_add_u32 s66, s71, 0
  buffer_load_dwordx4 v12, s[24:27], s66 offen lds
  buffer_load_dwordx4 v13, s[24:27], s66 offen offset:1024 lds
  s_waitcnt lgkmcnt(0)
  v_mfma_f32_16x16x32_bf16 v[120:123], v[116:119], v[32:35], v[120:123]
  v_mfma_f32_16x16x32_bf16 v[120:123], v[116:119], v[36:39], v[120:123]
  v_mfma_f32_16x16x32_bf16 v[120:123], v[116:119], v[40:43], v[120:123]
  v_mfma_f32_16x16x32_bf16 v[120:123], v[116:119], v[44:47], v[120:123]
  s_add_u32 m0, s68, 90112
  s_add_u32 s66, s71, 802816
  buffer_load_dwordx4 v12, s[24:27], s66 offen lds
  buffer_load_dwordx4 v13, s[24:27], s66 offen offset:1024 lds
  s_waitcnt vmcnt(16)
  s_barrier
  ds_read_b64_tr_b16 v[32:33], v28 offset:16384
  ds_read_b64_tr_b16 v[34:35], v28 offset:16896
  ds_read_b64_tr_b16 v[36:37], v28 offset:20480
  ds_read_b64_tr_b16 v[38:39], v28 offset:20992
  ds_read_b64_tr_b16 v[40:41], v28 offset:24576
  ds_read_b64_tr_b16 v[42:43], v28 offset:25088
  ds_read_b64_tr_b16 v[44:45], v28 offset:28672
  ds_read_b64_tr_b16 v[46:47], v28 offset:29184
  s_add_u32 m0, s68, 98304
  s_add_u32 s66, s71, 14336
  buffer_load_dwordx4 v12, s[24:27], s66 offen lds
  buffer_load_dwordx4 v13, s[24:27], s66 offen offset:1024 lds
  s_waitcnt lgkmcnt(0)
  v_mfma_f32_16x16x32_bf16 v[120:123], v[116:119], v[32:35], v[120:123]
  v_mfma_f32_16x16x32_bf16 v[120:123], v[116:119], v[36:39], v[120:123]
  v_mfma_f32_16x16x32_bf16 v[124:127], v[116:119], v[40:43], 0
  v_mfma_f32_16x16x32_bf16 v[124:127], v[116:119], v[44:47], v[124:127]
  s_add_u32 m0, s68, 106496
  s_add_u32 s66, s71, 817152
  buffer_load_dwordx4 v12, s[24:27], s66 offen lds
  buffer_load_dwordx4 v13, s[24:27], s66 offen offset:1024 lds
  s_nop 1
  v_and_b32 v121, 0xffff0000, v120
  v_sub_f32 v122, v120, v121
  v_and_b32 v123, 0xffff0000, v122
  v_lshrrev_b32 v121, 16, v121
  v_sub_f32 v122, v122, v123
  v_or_b32 v120, v121, v123
  v_lshrrev_b32 v121, 16, v122
  v_or_b32 v121, v112, v121
  ds_write_b64 v109, v[120:121]
  s_waitcnt vmcnt(8) lgkmcnt(0)
  s_barrier
  ds_read_b64_tr_b16 v[32:33], v28 offset:32768
  ds_read_b64_tr_b16 v[34:35], v28 offset:33280
  ds_read_b64_tr_b16 v[36:37], v28 offset:36864
  ds_read_b64_tr_b16 v[38:39], v28 offset:37376
  ds_read_b64_tr_b16 v[40:41], v28 offset:40960
  ds_read_b64_tr_b16 v[42:43], v28 offset:41472
  ds_read_b64_tr_b16 v[44:45], v28 offset:45056
  ds_read_b64_tr_b16 v[46:47], v28 offset:45568
  s_add_u32 m0, s68, 114688
  s_add_u32 s66, s71, 28672
  buffer_load_dwordx4 v12, s[24:27], s66 offen lds
  buffer_load_dwordx4 v13, s[24:27], s66 offen offset:1024 lds
  s_waitcnt lgkmcnt(0)
  v_mfma_f32_16x16x32_bf16 v[124:127], v[116:119], v[32:35], v[124:127]
  v_mfma_f32_16x16x32_bf16 v[124:127], v[116:119], v[36:39], v[124:127]
  v_mfma_f32_16x16x32_bf16 v[124:127], v[116:119], v[40:43], v[124:127]
  v_mfma_f32_16x16x32_bf16 v[124:127], v[116:119], v[44:47], v[124:127]
  s_add_u32 m0, s68, 122880
  s_add_u32 s66, s71, 831488
  buffer_load_dwordx4 v12, s[24:27], s66 offen lds
  buffer_load_dwordx4 v13, s[24:27], s66 offen offset:1024 lds
  s_add_u32 m0, s68, 131072
  s_add_u32 s66, s71, 43008
  buffer_load_dwordx4 v12, s[24:27], s66 offen lds
  buffer_load_dwordx4 v13, s[24:27], s66 offen offset:1024 lds
  s_add_u32 m0, s68, 139264
  s_add_u32 s66, s71, 845824
  buffer_load_dwordx4 v12, s[24:27], s66 offen lds
  buffer_load_dwordx4 v13, s[24:27], s66 offen offset:1024 lds
  s_waitcnt vmcnt(8)
  ds_read_b64_tr_b16 v[128:129], v14 offset:0
  ds_read_b64_tr_b16 v[130:131], v14 offset:512
  ds_read_b64_tr_b16 v[132:133], v15 offset:0
  ds_read_b64_tr_b16 v[134:135], v15 offset:512
  ds_read_b64_tr_b16 v[136:137], v16 offset:0
  ds_read_b64_tr_b16 v[138:139], v16 offset:512
  ds_read_b64_tr_b16 v[140:141], v17 offset:0
  ds_read_b64_tr_b16 v[142:143], v17 offset:512
  buffer_load_dwordx2 v[114:115], v5, s[44:47], 0 offen sc1
  s_waitcnt lgkmcnt(0)
  s_barrier
  v_subrev_u32 v29, 16384, v29
  ds_read_b64_tr_b16 v[32:33], v28 offset:0
  ds_read_b64_tr_b16 v[34:35], v28 offset:512
  ds_read_b64_tr_b16 v[36:37], v28 offset:4096
  ds_read_b64_tr_b16 v[38:39], v28 offset:4608
  ds_read_b64_tr_b16 v[40:41], v28 offset:8192
  ds_read_b64_tr_b16 v[42:43], v28 offset:8704
  ds_read_b64_tr_b16 v[44:45], v28 offset:12288
  ds_read_b64_tr_b16 v[46:47], v28 offset:12800
  s_waitcnt vmcnt(0)
  v_cmp_ne_u64 vcc, v[114:115], v[6:7]
  s_mov_b32 s63, 0
  s_nop 0
  s_cmp_eq_u64 vcc, 0
  s_cbranch_scc1 Lok_4
Lpoll_3:
  buffer_load_dwordx2 v[114:115], v5, s[44:47], 0 offen sc1
  s_waitcnt vmcnt(0)
  v_cmp_ne_u64 vcc, v[114:115], v[6:7]
  s_add_u32 s63, s63, 1
  s_nop 0
  s_cmp_eq_u64 vcc, 0
  s_cbranch_scc1 Lok_4
  s_cmp_lt_u32 s63, 100000
  s_sleep 4
  s_cbranch_scc1 Lpoll_3
Lok_4:
  s_mul_i32 s63, s53, 6144
  s_add_u32 m0, s63, 40960
  s_add_i32 s66, s72, 0
  s_max_i32 s66, s66, 0
  s_mul_i32 s66, s66, 43008
  s_add_u32 s66, s66, s85
  buffer_load_dwordx4 v4, s[16:19], s66 offen offset:0 sc1 lds
  s_add_i32 s66, s72, 1
  s_max_i32 s66, s66, 0
  s_mul_i32 s66, s66, 43008
  s_add_u32 s66, s66, s85
  s_sub_u32 s66, s66, 1024
  buffer_load_dwordx4 v4, s[16:19], s66 offen offset:1024 sc1 lds
  s_waitcnt lgkmcnt(0)
  v_mfma_f32_16x16x32_bf16 v[124:127], v[116:119], v[32:35], v[124:127]
  v_mfma_f32_16x16x32_bf16 v[124:127], v[116:119], v[36:39], v[124:127]
  v_mfma_f32_16x16x32_bf16 v[124:127], v[116:119], v[40:43], v[124:127]
  v_mfma_f32_16x16x32_bf16 v[124:127], v[116:119], v[44:47], v[124:127]
  s_add_i32 s66, s72, 2
  s_max_i32 s66, s66, 0
  s_mul_i32 s66, s66, 43008
  s_add_u32 s66, s66, s85
  s_sub_u32 s66, s66, 2048
  buffer_load_dwordx4 v4, s[16:19], s66 offen offset:2048 sc1 lds
  s_mul_i32 s63, s53, 6144
  s_add_u32 m0, s63, 44032
  s_add_i32 s66, s72, 3
  s_max_i32 s66, s66, 0
  s_mul_i32 s66, s66, 43008
  s_add_u32 s66, s66, s85
  buffer_load_dwordx4 v4, s[16:19], s66 offen offset:0 sc1 lds
  s_add_i32 s66, s72, 4
  s_max_i32 s66, s66, 0
  s_mul_i32 s66, s66, 43008
  s_add_u32 s66, s66, s85
  s_sub_u32 s66, s66, 1024
  buffer_load_dwordx4 v4, s[16:19], s66 offen offset:1024 sc1 lds
  s_add_i32 s66, s72, 5
  s_max_i32 s66, s66, 0
  s_mul_i32 s66, s66, 43008
  s_add_u32 s66, s66, s85
  s_sub_u32 s66, s66, 2048
  buffer_load_dwordx4 v4, s[16:19], s66 offen offset:2048 sc1 lds
  s_mul_i32 s63, s53, 6144
  s_add_u32 m0, s63, 16384
  s_add_i32 s66, s72, 0
  s_max_i32 s66, s66, 0
  s_mul_i32 s66, s66, 43008
  s_add_u32 s66, s66, s85
  buffer_load_dwordx4 v21, s[16:19], s66 offen offset:0 sc1 lds
  s_add_i32 s66, s72, 1
  s_max_i32 s66, s66, 0
  s_mul_i32 s66, s66, 43008
  s_add_u32 s66, s66, s85
  s_sub_u32 s66, s66, 1024
  buffer_load_dwordx4 v21, s[16:19], s66 offen offset:1024 sc1 lds
  ds_read_b64_tr_b16 v[144:145], v14 offset:32768
  ds_read_b64_tr_b16 v[146:147], v14 offset:33280
  ds_read_b64_tr_b16 v[148:149], v15 offset:32768
  ds_read_b64_tr_b16 v[150:151], v15 offset:33280
  ds_read_b64_tr_b16 v[152:153], v16 offset:32768
  ds_read_b64_tr_b16 v[154:155], v16 offset:33280
  ds_read_b64_tr_b16 v[156:157], v17 offset:32768
  ds_read_b64_tr_b16 v[158:159], v17 offset:33280
  s_waitcnt lgkmcnt(0)
  s_barrier
  ds_read_b64_tr_b16 v[32:33], v29 offset:0
  ds_read_b64_tr_b16 v[34:35], v29 offset:512
  ds_read_b64_tr_b16 v[36:37], v29 offset:4096
  ds_read_b64_tr_b16 v[38:39], v29 offset:4608
  ds_read_b64_tr_b16 v[40:41], v29 offset:8192
  ds_read_b64_tr_b16 v[42:43], v29 offset:8704
  ds_read_b64_tr_b16 v[44:45], v29 offset:12288
  ds_read_b64_tr_b16 v[46:47], v29 offset:12800
  s_add_i32 s66, s72, 2
  s_max_i32 s66, s66, 0
  s_mul_i32 s66, s66, 43008
  s_add_u32 s66, s66, s85
  s_sub_u32 s66, s66, 2048
  buffer_load_dwordx4 v21, s[16:19], s66 offen offset:2048 sc1 lds
  s_mul_i32 s63, s53, 6144
  s_add_u32 m0, s63, 19456
  s_add_i32 s66, s72, 3
  s_max_i32 s66, s66, 0
  s_mul_i32 s66, s66, 43008
  s_add_u32 s66, s66, s85
  buffer_load_dwordx4 v21, s[16:19], s66 offen offset:0 sc1 lds
  s_waitcnt lgkmcnt(0)
  v_mfma_f32_16x16x32_bf16 v[124:127], v[116:119], v[32:35], v[124:127]
  v_mfma_f32_16x16x32_bf16 v[124:127], v[116:119], v[36:39], v[124:127]
  v_mfma_f32_16x16x32_bf16 v[124:127], v[116:119], v[40:43], v[124:127]
  v_mfma_f32_16x16x32_bf16 v[124:127], v[116:119], v[44:47], v[124:127]
  s_add_i32 s66, s72, 4
  s_max_i32 s66, s66, 0
  s_mul_i32 s66, s66, 43008
  s_add_u32 s66, s66, s85
  s_sub_u32 s66, s66, 1024
  buffer_load_dwordx4 v21, s[16:19], s66 offen offset:1024 sc1 lds
  s_add_i32 s66, s72, 5
  s_max_i32 s66, s66, 0
  s_mul_i32 s66, s66, 43008
  s_add_u32 s66, s66, s85
  s_sub_u32 s66, s66, 2048
  buffer_load_dwordx4 v21, s[16:19], s66 offen offset:2048 sc1 lds
  buffer_load_dwordx4 v[120:123], v4, s[16:19], s101 offen sc1
  s_add_u32 m0, s68, 81920
  s_add_u32 s66, s71, 57344
  buffer_load_dwordx4 v12, s[24:27], s66 offen lds
  buffer_load_dwordx4 v13, s[24:27], s66 offen offset:1024 lds
  s_add_u32 m0, s68, 90112
  s_add_u32 s66, s71, 860160
  buffer_load_dwordx4 v12, s[24:27], s66 offen lds
  buffer_load_dwordx4 v13, s[24:27], s66 offen offset:1024 lds
  s_add_u32 m0, s68, 98304
  s_add_u32 s66, s71, 71680
  buffer_load_dwordx4 v12, s[24:27], s66 offen lds
  buffer_load_dwordx4 v13, s[24:27], s66 offen offset:1024 lds
  s_add_u32 m0, s68, 106496
  s_add_u32 s66, s71, 874496
  buffer_load_dwordx4 v12, s[24:27], s66 offen lds
  buffer_load_dwordx4 v13, s[24:27], s66 offen offset:1024 lds
  v_and_b32 v125, 0xffff0000, v124
  v_sub_f32 v126, v124, v125
  v_and_b32 v127, 0xffff0000, v126
  v_lshrrev_b32 v125, 16, v125
  v_sub_f32 v126, v126, v127
  v_or_b32 v124, v125, v127
  v_lshrrev_b32 v125, 16, v126
  v_or_b32 v125, v113, v125
  ds_write_b64 v109, v[124:125] offset:512
  s_waitcnt lgkmcnt(0)
  s_barrier
  s_setprio 0
  s_branch L_att
L_comp:
  s_mov_b32 s22, 0x100
  s_mov_b32 s23, 0x20000
  s_or_b32 s59, s2, s52
  s_cbranch_scc1 L_notag
  s_memrealtime s[60:61]
  s_waitcnt lgkmcnt(0)
  s_or_b32 s60, s60, 1
  v_mov_b32 v64, s60
  v_mov_b32 v65, s61
  s_mov_b64 exec, 1
  buffer_store_dwordx2 v[64:65], off, s[20:23], 0 sc1
  s_mov_b64 exec, -1
L_notag:
  v_lshrrev_b32 v8, 1, v2
  v_lshrrev_b32 v10, 1, v3
  v_xor_b32 v8, v8, v10
  v_lshlrev_b32 v8, 4, v8
  v_and_b32 v9, 31, v1
  v_lshl_add_u32 v8, v9, 7, v8
  v_add_u32 v240, s67, v8
  v_xor_b32 v241, 32, v240
  v_xor_b32 v242, 64, v240
  v_xor_b32 v243, 96, v240
  v_bfe_u32 v8, v1, 2, 2
  v_lshl_add_u32 v9, v10, 3, v8
  v_lshl_or_b32 v8, v8, 1, v10
  v_and_b32 v64, 1, v3
  v_xor_b32 v8, v64, v8
  v_lshlrev_b32 v8, 5, v8
  v_and_b32 v65, 3, v1
  v_lshl_add_u32 v8, v65, 3, v8
  v_lshl_add_u32 v8, v9, 8, v8
  s_and_b32 s60, s56, 1
  s_lshl1_add_u32 s60, s60, 2048
  s_add_u32 s59, s60, 0
  s_lshl_b32 s59, s59, 5
  v_xor_b32 v244, s59, v8
  s_add_u32 s59, s60, 2
  s_lshl_b32 s59, s59, 5
  v_xor_b32 v245, s59, v8
  s_add_u32 s59, s60, 4
  s_lshl_b32 s59, s59, 5
  v_xor_b32 v246, s59, v8
  v_bfe_u32 v8, v1, 3, 1
  v_lshl_or_b32 v8, v8, 1, v10
  v_xor_b32 v8, v64, v8
  v_lshlrev_b32 v8, 5, v8
  v_lshl_add_u32 v8, v65, 3, v8
  v_lshl_add_u32 v28, v9, 7, v8
  v_xor_b32 v29, 64, v28
  v_add_u32 v30, 81920, v28
  v_add_u32 v31, 81920, v29
  s_lshl_b32 s64, s52, 11
  v_lshlrev_b32 v4, 4, v1
  s_lshl_b32 s65, s52, 10
  v_bfe_u32 v32, v1, 1, 2
  s_add_u32 s44, s16, 0x1000000
  s_addc_u32 s45, s17, 0
  v_and_b32 v9, 1, v3
  s_mov_b32 s14, 0x188000
  v_xor_b32 v32, v32, v9
  s_mov_b32 s15, 0x20000
  v_lshlrev_b32 v32, 5, v32
  s_mov_b32 s50, 0x62000
  v_and_b32 v8, 1, v1
  s_mov_b32 s51, 0x20000
  v_lshl_add_u32 v32, v8, 4, v32
  s_mov_b32 s26, 0x188000
  v_lshrrev_b32 v33, 3, v1
  s_mov_b32 s27, 0x20000
  v_mul_u32_u24 v12, 896, v33
  s_mov_b32 s42, 0x380
  v_add_u32 v12, v12, v32
  s_mov_b32 s43, 0x20000
  v_xor_b32 v13, 64, v12
  s_mov_b32 s34, 0x1c0000
  v_lshlrev_b32 v8, 7, v9
  s_mov_b32 s35, 0x20000
  v_xor_b32 v21, v4, v8
  s_mov_b32 s18, 0x540000
  v_add_u32 v21, 14336, v21
  s_mov_b32 s19, 0x20000
  v_lshrrev_b32 v8, 1, v3
  s_mov_b32 s46, 0x100000
  v_mul_u32_u24 v10, 3584, v8
  s_mov_b32 s47, 0x20000
  v_sub_u32 v20, v13, v10
  s_mov_b32 s22, 0x100
  v_add_u32 v20, 2560, v20
  s_mov_b32 s23, 0x20000
  v_mul_u32_u24 v10, 10752, v8
  s_and_b32 s79, s58, 1
  v_add_u32 v18, v12, v10
  s_lshl1_add_u32 s76, s57, s79
  v_add_u32 v19, v13, v10
  s_lshr_b32 s77, s58, 1
  v_add_u32 v19, 2560, v19
  s_mul_i32 s78, s76, 7
  v_add_u32 v13, 6144, v13
  s_lshr_b32 s78, s78, 1
  v_bfe_u32 v34, v1, 2, 2
  s_lshl3_add_u32 s60, s77, s52
  v_lshlrev_b32 v34, 7, v34
  s_mul_i32 s61, s53, 6
  v_and_b32 v10, 3, v1
  s_lshl3_add_u32 s61, s77, s61
  v_lshl_add_u32 v34, v10, 3, v34
  s_sub_i32 s72, s61, 16
  v_bfe_u32 v10, v1, 3, 2
  s_lshl2_add_u32 s61, s77, s53
  v_lshl_or_b32 v34, v10, 5, v34
  s_add_u32 s59, s65, 40960
  v_lshl_add_u32 v9, v9, 10, v34
  s_add_u32 s62, s65, 16384
  v_lshl_add_u32 v9, v8, 14, v9
  v_add_u32 v14, s64, v9
  v_add_u32 v14, 81920, v14
  v_xor_b32 v15, 32, v14
  v_xor_b32 v16, 64, v14
  v_xor_b32 v17, 96, v14
  v_add_u32 v22, s59, v4
  s_sub_i32 s80, 16, s60
  v_lshrrev_b32 v8, 2, v1
  s_mul_i32 s101, s60, 168
  v_and_b32 v9, 3, v1
  s_add_u32 s101, s101, s78
  v_add_u32 v9, s79, v9
  s_lshl_b32 s101, s101, 8
  v_lshrrev_b32 v10, 1, v9
  s_mul_i32 s39, s60, 72
  v_and_b32 v23, 1, v10
  s_add_u32 s39, s39, s76
  v_lshlrev_b32 v23, 3, v23
  s_add_u32 s39, s39, 56
  v_xor_b32 v23, v23, v8
  s_lshl_b32 s39, s39, 10
  v_lshlrev_b32 v23, 4, v23
  s_add_u32 s85, s78, 56
  v_lshl_add_u32 v23, v10, 8, v23
  s_lshl_b32 s85, s85, 8
  v_and_b32 v10, 1, v9
  s_and_b32 s66, s58, 3
  v_lshl_add_u32 v23, v10, 3, v23
  s_lshl2_add_u32 s81, s57, s66
  v_add_u32 v23, s62, v23
  s_lshr_b32 s82, s58, 2
  v_bfe_u32 v8, v1, 1, 2
  s_min_u32 s82, s82, 6
  v_min_u32 v8, 2, v8
  s_lshl_b32 s66, s82, 7
  v_lshl_add_u32 v8, v8, 1, s72
  s_mul_i32 s83, s52, 200704
  v_max_i32 v8, 0, v8
  s_add_u32 s83, s83, s66
  v_lshrrev_b32 v8, 1, v8
  s_mul_i32 s84, s52, 50176
  v_min_u32 v9, 2, v3
  s_add_u32 s84, s84, s66
  v_mov_b32 v10, s61
  s_lshl1_add_u32 s66, s77, s54
  v_cmp_eq_u32 vcc, 0, v9
  s_lshl4_add_u32 s66, s66, s76
  v_mul_u32_u24 v9, 56, v9
  s_lshl2_add_u32 s66, s66, s53
  v_cndmask_b32 v8, v8, v10, vcc
  s_lshl3_add_u32 s75, s66, 524288
  v_and_b32 v10, 1, v1
  v_mul_u32_u24 v10, 3, v10
  v_add3_u32 v9, v9, v10, s78
  v_mul_u32_u24 v9, 171, v9
  v_lshrrev_b32 v9, 11, v9
  v_lshl_add_u32 v8, v8, 4, v9
  v_lshlrev_b32 v5, 6, v8
  s_lshl2_add_u32 s59, s55, s53
  v_and_b32 v10, 1, v3
  s_mul_i32 s70, s59, 147456
  v_lshrrev_b32 v8, 1, v3
  s_lshl_b32 s60, s56, 12
  v_lshlrev_b32 v8, 8, v8
  s_add_u32 s70, s70, s60
  v_lshl_add_u32 v8, v2, 4, v8
  v_mul_u32_u24 v0, 73728, v10
  s_lshr_b32 s61, s59, 1
  v_add_u32 v0, v0, v8
  s_lshl_b32 s61, s61, 8
  s_lshl4_add_u32 s61, s56, s61
  s_and_b32 s60, s53, 1
  s_lshl3_add_u32 s61, s60, s61
  s_lshl_b32 s61, s61, 3
  s_add_u32 s74, s61, 262144
  s_add_u32 s28, s16, 0x600000
  s_addc_u32 s29, s17, 0
  s_mov_b32 s30, 0x900000
  s_mov_b32 s31, 0x20000
  v_mul_u32_u24 v5, 43008, v10
  s_lshl4_add_u32 s73, s59, s56
  v_add_u32 v5, v5, v8
  s_lshl_b32 s73, s73, 6
  s_mul_i32 s69, s59, 86016
  s_mul_i32 s61, s56, 3072
  s_add_u32 s69, s69, s61
  v_and_b32 v21, 31, v1
  v_lshlrev_b32 v21, 3, v21
  v_add_u32 v21, 147456, v21
  s_barrier
  ds_read_b128 v[128:131], v240 offset:0
  ds_read_b64_tr_b16 v[32:33], v244 offset:0
  ds_read_b64_tr_b16 v[34:35], v244 offset:1024
  ds_read_b64_tr_b16 v[36:37], v245 offset:0
  ds_read_b64_tr_b16 v[38:39], v245 offset:1024
  ds_read_b64_tr_b16 v[40:41], v246 offset:0
  ds_read_b64_tr_b16 v[42:43], v246 offset:1024
  ds_read_b128 v[132:135], v241 offset:0
  ds_read_b64_tr_b16 v[44:45], v244 offset:4096
  ds_read_b64_tr_b16 v[46:47], v244 offset:5120
  ds_read_b64_tr_b16 v[48:49], v245 offset:4096
  ds_read_b64_tr_b16 v[50:51], v245 offset:5120
  ds_read_b64_tr_b16 v[52:53], v246 offset:4096
  ds_read_b64_tr_b16 v[54:55], v246 offset:5120
  s_waitcnt lgkmcnt(7)
  v_mfma_f32_32x32x16_bf16 v[80:95], v[32:35], v[128:131], 0
  ds_read_b128 v[136:139], v242 offset:0
  ds_read_b64_tr_b16 v[56:57], v244 offset:8192
  ds_read_b64_tr_b16 v[58:59], v244 offset:9216
  v_mfma_f32_32x32x16_bf16 v[96:111], v[36:39], v[128:131], 0
  ds_read_b64_tr_b16 v[60:61], v245 offset:8192
  ds_read_b64_tr_b16 v[62:63], v245 offset:9216
  ds_read_b64_tr_b16 v[64:65], v246 offset:8192
  v_mfma_f32_32x32x16_bf16 v[112:127], v[40:43], v[128:131], 0
  ds_read_b64_tr_b16 v[66:67], v246 offset:9216
  ds_read_b128 v[140:143], v243 offset:0
  ds_read_b64_tr_b16 v[68:69], v244 offset:12288
  s_waitcnt lgkmcnt(9)
  v_mfma_f32_32x32x16_bf16 v[80:95], v[44:47], v[132:135], v[80:95]
  ds_read_b64_tr_b16 v[70:71], v244 offset:13312
  ds_read_b64_tr_b16 v[72:73], v245 offset:12288
  ds_read_b64_tr_b16 v[74:75], v245 offset:13312
  v_mfma_f32_32x32x16_bf16 v[96:111], v[48:51], v[132:135], v[96:111]
  ds_read_b64_tr_b16 v[76:77], v246 offset:12288
  ds_read_b64_tr_b16 v[78:79], v246 offset:13312
  v_mfma_f32_32x32x16_bf16 v[112:127], v[52:55], v[132:135], v[112:127]
  s_waitcnt lgkmcnt(0)
  s_barrier
  v_mfma_f32_32x32x16_bf16 v[80:95], v[56:59], v[136:139], v[80:95]
  ds_read_b128 v[144:147], v240 offset:16384
  ds_read_b64_tr_b16 v[32:33], v244 offset:16384
  ds_read_b64_tr_b16 v[34:35], v244 offset:17408
  v_mfma_f32_32x32x16_bf16 v[96:111], v[60:63], v[136:139], v[96:111]
  ds_read_b64_tr_b16 v[36:37], v245 offset:16384
  ds_read_b64_tr_b16 v[38:39], v245 offset:17408
  ds_read_b64_tr_b16 v[40:41], v246 offset:16384
  v_mfma_f32_32x32x16_bf16 v[112:127], v[64:67], v[136:139], v[112:127]
  ds_read_b64_tr_b16 v[42:43], v246 offset:17408
  ds_read_b128 v[148:151], v241 offset:16384
  ds_read_b64_tr_b16 v[44:45], v244 offset:20480
  v_mfma_f32_32x32x16_bf16 v[80:95], v[68:71], v[140:143], v[80:95]
  ds_read_b64_tr_b16 v[46:47], v244 offset:21504
  ds_read_b64_tr_b16 v[48:49], v245 offset:20480
  ds_read_b64_tr_b16 v[50:51], v245 offset:21504
  v_mfma_f32_32x32x16_bf16 v[96:111], v[72:75], v[140:143], v[96:111]
  ds_read_b64_tr_b16 v[52:53], v246 offset:20480
  ds_read_b64_tr_b16 v[54:55], v246 offset:21504
  v_mfma_f32_32x32x16_bf16 v[112:127], v[76:79], v[140:143], v[112:127]
  s_waitcnt lgkmcnt(7)
  v_mfma_f32_32x32x16_bf16 v[80:95], v[32:35], v[144:147], v[80:95]
  ds_read_b128 v[152:155], v242 offset:16384
  ds_read_b64_tr_b16 v[56:57], v244 offset:24576
  ds_read_b64_tr_b16 v[58:59], v244 offset:25600
  v_mfma_f32_32x32x16_bf16 v[96:111], v[36:39], v[144:147], v[96:111]
  ds_read_b64_tr_b16 v[60:61], v245 offset:24576
  ds_read_b64_tr_b16 v[62:63], v245 offset:25600
  ds_read_b64_tr_b16 v[64:65], v246 offset:24576
  v_mfma_f32_32x32x16_bf16 v[112:127], v[40:43], v[144:147], v[112:127]
  ds_read_b64_tr_b16 v[66:67], v246 offset:25600
  ds_read_b128 v[156:159], v243 offset:16384
  ds_read_b64_tr_b16 v[68:69], v244 offset:28672
  s_waitcnt lgkmcnt(9)
  v_mfma_f32_32x32x16_bf16 v[80:95], v[44:47], v[148:151], v[80:95]
  ds_read_b64_tr_b16 v[70:71], v244 offset:29696
  ds_read_b64_tr_b16 v[72:73], v245 offset:28672
  ds_read_b64_tr_b16 v[74:75], v245 offset:29696
  v_mfma_f32_32x32x16_bf16 v[96:111], v[48:51], v[148:151], v[96:111]
  ds_read_b64_tr_b16 v[76:77], v246 offset:28672
  ds_read_b64_tr_b16 v[78:79], v246 offset:29696
  v_mfma_f32_32x32x16_bf16 v[112:127], v[52:55], v[148:151], v[112:127]
  s_waitcnt lgkmcnt(0)
  s_barrier
  v_mfma_f32_32x32x16_bf16 v[80:95], v[56:59], v[152:155], v[80:95]
  ds_read_b128 v[160:163], v240 offset:32768
  ds_read_b64_tr_b16 v[32:33], v244 offset:32768
  ds_read_b64_tr_b16 v[34:35], v244 offset:33792
  v_mfma_f32_32x32x16_bf16 v[96:111], v[60:63], v[152:155], v[96:111]
  ds_read_b64_tr_b16 v[36:37], v245 offset:32768
  ds_read_b64_tr_b16 v[38:39], v245 offset:33792
  ds_read_b64_tr_b16 v[40:41], v246 offset:32768
  v_mfma_f32_32x32x16_bf16 v[112:127], v[64:67], v[152:155], v[112:127]
  ds_read_b64_tr_b16 v[42:43], v246 offset:33792
  ds_read_b128 v[164:167], v241 offset:32768
  ds_read_b64_tr_b16 v[44:45], v244 offset:36864
  v_mfma_f32_32x32x16_bf16 v[80:95], v[68:71], v[156:159], v[80:95]
  ds_read_b64_tr_b16 v[46:47], v244 offset:37888
  ds_read_b64_tr_b16 v[48:49], v245 offset:36864
  ds_read_b64_tr_b16 v[50:51], v245 offset:37888
  v_mfma_f32_32x32x16_bf16 v[96:111], v[72:75], v[156:159], v[96:111]
  ds_read_b64_tr_b16 v[52:53], v246 offset:36864
  ds_read_b64_tr_b16 v[54:55], v246 offset:37888
  v_mfma_f32_32x32x16_bf16 v[112:127], v[76:79], v[156:159], v[112:127]
  s_waitcnt lgkmcnt(7)
  v_mfma_f32_32x32x16_bf16 v[80:95], v[32:35], v[160:163], v[80:95]
  ds_read_b128 v[168:171], v242 offset:32768
  ds_read_b64_tr_b16 v[56:57], v244 offset:40960
  ds_read_b64_tr_b16 v[58:59], v244 offset:41984
  v_mfma_f32_32x32x16_bf16 v[96:111], v[36:39], v[160:163], v[96:111]
  ds_read_b64_tr_b16 v[60:61], v245 offset:40960
  ds_read_b64_tr_b16 v[62:63], v245 offset:41984
  ds_read_b64_tr_b16 v[64:65], v246 offset:40960
  v_mfma_f32_32x32x16_bf16 v[112:127], v[40:43], v[160:163], v[112:127]
  ds_read_b64_tr_b16 v[66:67], v246 offset:41984
  ds_read_b128 v[172:175], v243 offset:32768
  ds_read_b64_tr_b16 v[68:69], v244 offset:45056
  s_waitcnt lgkmcnt(9)
  v_mfma_f32_32x32x16_bf16 v[80:95], v[44:47], v[164:167], v[80:95]
  ds_read_b64_tr_b16 v[70:71], v244 offset:46080
  ds_read_b64_tr_b16 v[72:73], v245 offset:45056
  ds_read_b64_tr_b16 v[74:75], v245 offset:46080
  v_mfma_f32_32x32x16_bf16 v[96:111], v[48:51], v[164:167], v[96:111]
  ds_read_b64_tr_b16 v[76:77], v246 offset:45056
  ds_read_b64_tr_b16 v[78:79], v246 offset:46080
  v_mfma_f32_32x32x16_bf16 v[112:127], v[52:55], v[164:167], v[112:127]
  s_waitcnt lgkmcnt(0)
  s_barrier
  v_mfma_f32_32x32x16_bf16 v[80:95], v[56:59], v[168:171], v[80:95]
  ds_read_b128 v[176:179], v240 offset:0
  ds_read_b64_tr_b16 v[32:33], v244 offset:0
  ds_read_b64_tr_b16 v[34:35], v244 offset:1024
  v_mfma_f32_32x32x16_bf16 v[96:111], v[60:63], v[168:171], v[96:111]
  ds_read_b64_tr_b16 v[36:37], v245 offset:0
  ds_read_b64_tr_b16 v[38:39], v245 offset:1024
  ds_read_b64_tr_b16 v[40:41], v246 offset:0
  v_mfma_f32_32x32x16_bf16 v[112:127], v[64:67], v[168:171], v[112:127]
  ds_read_b64_tr_b16 v[42:43], v246 offset:1024
  ds_read_b128 v[180:183], v241 offset:0
  ds_read_b64_tr_b16 v[44:45], v244 offset:4096
  v_mfma_f32_32x32x16_bf16 v[80:95], v[68:71], v[172:175], v[80:95]
  ds_read_b64_tr_b16 v[46:47], v244 offset:5120
  ds_read_b64_tr_b16 v[48:49], v245 offset:4096
  ds_read_b64_tr_b16 v[50:51], v245 offset:5120
  v_mfma_f32_32x32x16_bf16 v[96:111], v[72:75], v[172:175], v[96:111]
  ds_read_b64_tr_b16 v[52:53], v246 offset:4096
  ds_read_b64_tr_b16 v[54:55], v246 offset:5120
  v_mfma_f32_32x32x16_bf16 v[112:127], v[76:79], v[172:175], v[112:127]
  s_waitcnt lgkmcnt(7)
  v_mfma_f32_32x32x16_bf16 v[80:95], v[32:35], v[176:179], v[80:95]
  ds_read_b128 v[184:187], v242 offset:0
  ds_read_b64_tr_b16 v[56:57], v244 offset:8192
  ds_read_b64_tr_b16 v[58:59], v244 offset:9216
  v_mfma_f32_32x32x16_bf16 v[96:111], v[36:39], v[176:179], v[96:111]
  ds_read_b64_tr_b16 v[60:61], v245 offset:8192
  ds_read_b64_tr_b16 v[62:63], v245 offset:9216
  ds_read_b64_tr_b16 v[64:65], v246 offset:8192
  v_mfma_f32_32x32x16_bf16 v[112:127], v[40:43], v[176:179], v[112:127]
  ds_read_b64_tr_b16 v[66:67], v246 offset:9216
  ds_read_b128 v[188:191], v243 offset:0
  ds_read_b64_tr_b16 v[68:69], v244 offset:12288
  s_waitcnt lgkmcnt(9)
  v_mfma_f32_32x32x16_bf16 v[80:95], v[44:47], v[180:183], v[80:95]
  ds_read_b64_tr_b16 v[70:71], v244 offset:13312
  ds_read_b64_tr_b16 v[72:73], v245 offset:12288
  ds_read_b64_tr_b16 v[74:75], v245 offset:13312
  v_mfma_f32_32x32x16_bf16 v[96:111], v[48:51], v[180:183], v[96:111]
  ds_read_b64_tr_b16 v[76:77], v246 offset:12288
  ds_read_b64_tr_b16 v[78:79], v246 offset:13312
  v_mfma_f32_32x32x16_bf16 v[112:127], v[52:55], v[180:183], v[112:127]
  s_waitcnt lgkmcnt(0)
  s_barrier
  v_mfma_f32_32x32x16_bf16 v[80:95], v[56:59], v[184:187], v[80:95]
  ds_read_b128 v[192:195], v240 offset:16384
  ds_read_b64_tr_b16 v[32:33], v244 offset:16384
  ds_read_b64_tr_b16 v[34:35], v244 offset:17408
  v_mfma_f32_32x32x16_bf16 v[96:111], v[60:63], v[184:187], v[96:111]
  ds_read_b64_tr_b16 v[36:37], v245 offset:16384
  ds_read_b64_tr_b16 v[38:39], v245 offset:17408
  ds_read_b64_tr_b16 v[40:41], v246 offset:16384
  v_mfma_f32_32x32x16_bf16 v[112:127], v[64:67], v[184:187], v[112:127]
  ds_read_b64_tr_b16 v[42:43], v246 offset:17408
  ds_read_b128 v[196:199], v241 offset:16384
  ds_read_b64_tr_b16 v[44:45], v244 offset:20480
  v_mfma_f32_32x32x16_bf16 v[80:95], v[68:71], v[188:191], v[80:95]
  ds_read_b64_tr_b16 v[46:47], v244 offset:21504
  ds_read_b64_tr_b16 v[48:49], v245 offset:20480
  ds_read_b64_tr_b16 v[50:51], v245 offset:21504
  v_mfma_f32_32x32x16_bf16 v[96:111], v[72:75], v[188:191], v[96:111]
  ds_read_b64_tr_b16 v[52:53], v246 offset:20480
  ds_read_b64_tr_b16 v[54:55], v246 offset:21504
  v_mfma_f32_32x32x16_bf16 v[112:127], v[76:79], v[188:191], v[112:127]
  s_waitcnt lgkmcnt(7)
  v_mfma_f32_32x32x16_bf16 v[80:95], v[32:35], v[192:195], v[80:95]
  ds_read_b128 v[200:203], v242 offset:16384
  ds_read_b64_tr_b16 v[56:57], v244 offset:24576
  ds_read_b64_tr_b16 v[58:59], v244 offset:25600
  v_mfma_f32_32x32x16_bf16 v[96:111], v[36:39], v[192:195], v[96:111]
  ds_read_b64_tr_b16 v[60:61], v245 offset:24576
  ds_read_b64_tr_b16 v[62:63], v245 offset:25600
  ds_read_b64_tr_b16 v[64:65], v246 offset:24576
  v_mfma_f32_32x32x16_bf16 v[112:127], v[40:43], v[192:195], v[112:127]
  ds_read_b64_tr_b16 v[66:67], v246 offset:25600
  ds_read_b128 v[204:207], v243 offset:16384
  ds_read_b64_tr_b16 v[68:69], v244 offset:28672
  s_waitcnt lgkmcnt(9)
  v_mfma_f32_32x32x16_bf16 v[80:95], v[44:47], v[196:199], v[80:95]
  ds_read_b64_tr_b16 v[70:71], v244 offset:29696
  ds_read_b64_tr_b16 v[72:73], v245 offset:28672
  ds_read_b64_tr_b16 v[74:75], v245 offset:29696
  v_mfma_f32_32x32x16_bf16 v[96:111], v[48:51], v[196:199], v[96:111]
  ds_read_b64_tr_b16 v[76:77], v246 offset:28672
  ds_read_b64_tr_b16 v[78:79], v246 offset:29696
  v_mfma_f32_32x32x16_bf16 v[112:127], v[52:55], v[196:199], v[112:127]
  s_waitcnt lgkmcnt(0)
  s_barrier
  v_mfma_f32_32x32x16_bf16 v[80:95], v[56:59], v[200:203], v[80:95]
  ds_read_b128 v[208:211], v240 offset:32768
  ds_read_b64_tr_b16 v[32:33], v244 offset:32768
  ds_read_b64_tr_b16 v[34:35], v244 offset:33792
  v_mfma_f32_32x32x16_bf16 v[96:111], v[60:63], v[200:203], v[96:111]
  ds_read_b64_tr_b16 v[36:37], v245 offset:32768
  ds_read_b64_tr_b16 v[38:39], v245 offset:33792
  ds_read_b64_tr_b16 v[40:41], v246 offset:32768
  v_mfma_f32_32x32x16_bf16 v[112:127], v[64:67], v[200:203], v[112:127]
  ds_read_b64_tr_b16 v[42:43], v246 offset:33792
  ds_read_b128 v[212:215], v241 offset:32768
  ds_read_b64_tr_b16 v[44:45], v244 offset:36864
  v_mfma_f32_32x32x16_bf16 v[80:95], v[68:71], v[204:207], v[80:95]
  ds_read_b64_tr_b16 v[46:47], v244 offset:37888
  ds_read_b64_tr_b16 v[48:49], v245 offset:36864
  ds_read_b64_tr_b16 v[50:51], v245 offset:37888
  v_mfma_f32_32x32x16_bf16 v[96:111], v[72:75], v[204:207], v[96:111]
  ds_read_b64_tr_b16 v[52:53], v246 offset:36864
  ds_read_b64_tr_b16 v[54:55], v246 offset:37888
  v_mfma_f32_32x32x16_bf16 v[112:127], v[76:79], v[204:207], v[112:127]
  s_waitcnt lgkmcnt(7)
  v_mfma_f32_32x32x16_bf16 v[80:95], v[32:35], v[208:211], v[80:95]
  ds_read_b128 v[216:219], v242 offset:32768
  ds_read_b64_tr_b16 v[56:57], v244 offset:40960
  ds_read_b64_tr_b16 v[58:59], v244 offset:41984
  v_mfma_f32_32x32x16_bf16 v[96:111], v[36:39], v[208:211], v[96:111]
  ds_read_b64_tr_b16 v[60:61], v245 offset:40960
  ds_read_b64_tr_b16 v[62:63], v245 offset:41984
  ds_read_b64_tr_b16 v[64:65], v246 offset:40960
  v_mfma_f32_32x32x16_bf16 v[112:127], v[40:43], v[208:211], v[112:127]
  ds_read_b64_tr_b16 v[66:67], v246 offset:41984
  ds_read_b128 v[220:223], v243 offset:32768
  ds_read_b64_tr_b16 v[68:69], v244 offset:45056
  s_waitcnt lgkmcnt(9)
  v_mfma_f32_32x32x16_bf16 v[80:95], v[44:47], v[212:215], v[80:95]
  ds_read_b64_tr_b16 v[70:71], v244 offset:46080
  ds_read_b64_tr_b16 v[72:73], v245 offset:45056
  ds_read_b64_tr_b16 v[74:75], v245 offset:46080
  v_mfma_f32_32x32x16_bf16 v[96:111], v[48:51], v[212:215], v[96:111]
  ds_read_b64_tr_b16 v[76:77], v246 offset:45056
  ds_read_b64_tr_b16 v[78:79], v246 offset:46080
  v_mfma_f32_32x32x16_bf16 v[112:127], v[52:55], v[212:215], v[112:127]
  s_waitcnt lgkmcnt(0)
  s_barrier
  v_mfma_f32_32x32x16_bf16 v[80:95], v[56:59], v[216:219], v[80:95]
  ds_read_b128 v[224:227], v240 offset:0
  ds_read_b64_tr_b16 v[32:33], v244 offset:0
  ds_read_b64_tr_b16 v[34:35], v244 offset:1024
  v_mfma_f32_32x32x16_bf16 v[96:111], v[60:63], v[216:219], v[96:111]
  ds_read_b64_tr_b16 v[36:37], v245 offset:0
  ds_read_b64_tr_b16 v[38:39], v245 offset:1024
  ds_read_b64_tr_b16 v[40:41], v246 offset:0
  v_mfma_f32_32x32x16_bf16 v[112:127], v[64:67], v[216:219], v[112:127]
  ds_read_b64_tr_b16 v[42:43], v246 offset:1024
  ds_read_b128 v[228:231], v241 offset:0
  ds_read_b64_tr_b16 v[44:45], v244 offset:4096
  v_mfma_f32_32x32x16_bf16 v[80:95], v[68:71], v[220:223], v[80:95]
  ds_read_b64_tr_b16 v[46:47], v244 offset:5120
  ds_read_b64_tr_b16 v[48:49], v245 offset:4096
  ds_read_b64_tr_b16 v[50:51], v245 offset:5120
  v_mfma_f32_32x32x16_bf16 v[96:111], v[72:75], v[220:223], v[96:111]
  ds_read_b64_tr_b16 v[52:53], v246 offset:4096
  ds_read_b64_tr_b16 v[54:55], v246 offset:5120
  v_mfma_f32_32x32x16_bf16 v[112:127], v[76:79], v[220:223], v[112:127]
  s_waitcnt lgkmcnt(7)
  v_mfma_f32_32x32x16_bf16 v[80:95], v[32:35], v[224:227], v[80:95]
  ds_read_b128 v[232:235], v242 offset:0
  ds_read_b64_tr_b16 v[56:57], v244 offset:8192
  ds_read_b64_tr_b16 v[58:59], v244 offset:9216
  v_mfma_f32_32x32x16_bf16 v[96:111], v[36:39], v[224:227], v[96:111]
  ds_read_b64_tr_b16 v[60:61], v245 offset:8192
  ds_read_b64_tr_b16 v[62:63], v245 offset:9216
  ds_read_b64_tr_b16 v[64:65], v246 offset:8192
  v_mfma_f32_32x32x16_bf16 v[112:127], v[40:43], v[224:227], v[112:127]
  ds_read_b64_tr_b16 v[66:67], v246 offset:9216
  ds_read_b128 v[236:239], v243 offset:0
  ds_read_b64_tr_b16 v[68:69], v244 offset:12288
  s_waitcnt lgkmcnt(9)
  v_mfma_f32_32x32x16_bf16 v[80:95], v[44:47], v[228:231], v[80:95]
  ds_read_b64_tr_b16 v[70:71], v244 offset:13312
  ds_read_b64_tr_b16 v[72:73], v245 offset:12288
  ds_read_b64_tr_b16 v[74:75], v245 offset:13312
  v_mfma_f32_32x32x16_bf16 v[96:111], v[48:51], v[228:231], v[96:111]
  ds_read_b64_tr_b16 v[76:77], v246 offset:12288
  ds_read_b64_tr_b16 v[78:79], v246 offset:13312
  v_mfma_f32_32x32x16_bf16 v[112:127], v[52:55], v[228:231], v[112:127]
  s_waitcnt lgkmcnt(0)
  s_barrier
  v_mfma_f32_32x32x16_bf16 v[80:95], v[56:59], v[232:235], v[80:95]
  ds_read_b64_tr_b16 v[32:33], v28 offset:49152
  ds_read_b64_tr_b16 v[34:35], v28 offset:49664
  ds_read_b64_tr_b16 v[36:37], v29 offset:49152
  v_mfma_f32_32x32x16_bf16 v[96:111], v[60:63], v[232:235], v[96:111]
  ds_read_b64_tr_b16 v[38:39], v29 offset:49664
  ds_read_b64_tr_b16 v[40:41], v28 offset:51200
  v_mfma_f32_32x32x16_bf16 v[112:127], v[64:67], v[232:235], v[112:127]
  ds_read_b64_tr_b16 v[42:43], v28 offset:51712
  ds_read_b64_tr_b16 v[44:45], v29 offset:51200
  ds_read_b64_tr_b16 v[46:47], v29 offset:51712
  v_mfma_f32_32x32x16_bf16 v[80:95], v[68:71], v[236:239], v[80:95]
  ds_read_b64_tr_b16 v[48:49], v28 offset:53248
  ds_read_b64_tr_b16 v[50:51], v28 offset:53760
  v_mfma_f32_32x32x16_bf16 v[96:111], v[72:75], v[236:239], v[96:111]
  ds_read_b64_tr_b16 v[52:53], v29 offset:53248
  ds_read_b64_tr_b16 v[54:55], v29 offset:53760
  v_mfma_f32_32x32x16_bf16 v[112:127], v[76:79], v[236:239], v[112:127]
  ds_read_b64_tr_b16 v[56:57], v28 offset:55296
  ds_read_b64_tr_b16 v[58:59], v28 offset:55808
  ds_read_b64_tr_b16 v[60:61], v29 offset:55296
  ds_read_b64_tr_b16 v[62:63], v29 offset:55808
  s_waitcnt lgkmcnt(12)
  v_mfma_f32_32x32x16_bf16 v[64:79], v[32:35], v[128:131], 0
  ds_read_b64_tr_b16 v[32:33], v28 offset:57344
  ds_read_b64_tr_b16 v[34:35], v28 offset:57856
  v_mfma_f32_32x32x16_bf16 v[240:255], v[36:39], v[128:131], 0
  ds_read_b64_tr_b16 v[36:37], v29 offset:57344
  ds_read_b64_tr_b16 v[38:39], v29 offset:57856
  s_waitcnt lgkmcnt(12)
  v_mfma_f32_32x32x16_bf16 v[64:79], v[40:43], v[132:135], v[64:79]
  ds_read_b64_tr_b16 v[40:41], v28 offset:59392
  ds_read_b64_tr_b16 v[42:43], v28 offset:59904
  v_mfma_f32_32x32x16_bf16 v[240:255], v[44:47], v[132:135], v[240:255]
  ds_read_b64_tr_b16 v[44:45], v29 offset:59392
  ds_read_b64_tr_b16 v[46:47], v29 offset:59904
  v_mov_b32 v10, 153600
  ds_read_b64 v[6:7], v10
  s_waitcnt lgkmcnt(13)
  v_mfma_f32_32x32x16_bf16 v[64:79], v[48:51], v[136:139], v[64:79]
  ds_read_b64_tr_b16 v[48:49], v28 offset:61440
  ds_read_b64_tr_b16 v[50:51], v28 offset:61952
  v_mfma_f32_32x32x16_bf16 v[240:255], v[52:55], v[136:139], v[240:255]
  ds_read_b64_tr_b16 v[52:53], v29 offset:61440
  ds_read_b64_tr_b16 v[54:55], v29 offset:61952
  s_waitcnt lgkmcnt(13)
  v_mfma_f32_32x32x16_bf16 v[64:79], v[56:59], v[140:143], v[64:79]
  ds_read_b64_tr_b16 v[56:57], v28 offset:63488
  ds_read_b64_tr_b16 v[58:59], v28 offset:64000
  v_mfma_f32_32x32x16_bf16 v[240:255], v[60:63], v[140:143], v[240:255]
  ds_read_b64_tr_b16 v[60:61], v29 offset:63488
  ds_read_b64_tr_b16 v[62:63], v29 offset:64000
  s_barrier
  s_waitcnt lgkmcnt(13)
  v_mfma_f32_32x32x16_bf16 v[64:79], v[32:35], v[144:147], v[64:79]
  ds_read_b64_tr_b16 v[32:33], v30 offset:32768
  ds_read_b64_tr_b16 v[34:35], v30 offset:33280
  s_lshl_b32 s59, s53, 9
  s_add_u32 s59, s59, -145408
  v_lshl_add_u32 v10, v21, 1, s59
  ds_read_b128 v[24:27], v10
  v_lshrrev_b32 v10, 1, v3
  v_add_u32 v10, -1, v10
  s_mul_i32 s59, s56, 6
  v_mfma_f32_32x32x16_bf16 v[240:255], v[36:39], v[144:147], v[240:255]
  ds_read_b64_tr_b16 v[36:37], v31 offset:32768
  ds_read_b64_tr_b16 v[38:39], v31 offset:33280
  s_waitcnt lgkmcnt(2)
  v_and_b32 v24, v10, v24
  v_and_b32 v25, v10, v25
  ds_read_b64 v[8:9], v21 offset:1024
  s_waitcnt lgkmcnt(0)
  v_mfma_f32_32x32x8_bf16 v[80:95], v[8:9], v[24:25], v[80:95]
  v_mfma_f32_32x32x16_bf16 v[64:79], v[40:43], v[148:151], v[64:79]
  ds_read_b64_tr_b16 v[40:41], v30 offset:34816
  ds_read_b64_tr_b16 v[42:43], v30 offset:35328
  ds_read_b64 v[8:9], v21 offset:1280
  s_waitcnt lgkmcnt(0)
  v_mfma_f32_32x32x8_bf16 v[96:111], v[8:9], v[24:25], v[96:111]
  v_mfma_f32_32x32x16_bf16 v[240:255], v[44:47], v[148:151], v[240:255]
  ds_read_b64_tr_b16 v[44:45], v31 offset:34816
  ds_read_b64_tr_b16 v[46:47], v31 offset:35328
  ds_read_b64 v[8:9], v21 offset:1536
  s_waitcnt lgkmcnt(0)
  v_mfma_f32_32x32x8_bf16 v[112:127], v[8:9], v[24:25], v[112:127]
  s_cmp_lt_u32 s59, 28
  s_cselect_b32 s60, 0x3e8b97f6, 1.0
  v_mfma_f32_32x32x16_bf16 v[64:79], v[48:51], v[152:155], v[64:79]
  ds_read_b64_tr_b16 v[48:49], v30 offset:36864
  ds_read_b64_tr_b16 v[50:51], v30 offset:37376
  v_mul_f32 v10, s60, v26
  v_mul_f32 v80, v10, v80
  v_mul_f32 v81, v10, v81
  v_mul_f32 v82, v10, v82
  v_mul_f32 v83, v10, v83
  v_mul_f32 v84, v10, v84
  v_mul_f32 v85, v10, v85
  v_mul_f32 v86, v10, v86
  v_mfma_f32_32x32x16_bf16 v[240:255], v[52:55], v[152:155], v[240:255]
  ds_read_b64_tr_b16 v[52:53], v31 offset:36864
  ds_read_b64_tr_b16 v[54:55], v31 offset:37376
  v_mul_f32 v87, v10, v87
  v_mul_f32 v88, v10, v88
  v_mul_f32 v89, v10, v89
  v_mul_f32 v90, v10, v90
  v_mul_f32 v91, v10, v91
  v_mul_f32 v92, v10, v92
  v_mul_f32 v93, v10, v93
  v_mul_f32 v94, v10, v94
  v_mfma_f32_32x32x16_bf16 v[64:79], v[56:59], v[156:159], v[64:79]
  ds_read_b64_tr_b16 v[56:57], v30 offset:38912
  ds_read_b64_tr_b16 v[58:59], v30 offset:39424
  v_mul_f32 v95, v10, v95
  v_cvt_pk_bf16_f32 v80, v80, v81
  v_cvt_pk_bf16_f32 v81, v82, v83
  v_cvt_pk_bf16_f32 v82, v84, v85
  v_cvt_pk_bf16_f32 v83, v86, v87
  v_cvt_pk_bf16_f32 v88, v88, v89
  v_cvt_pk_bf16_f32 v89, v90, v91
  v_cvt_pk_bf16_f32 v90, v92, v93
  v_mfma_f32_32x32x16_bf16 v[240:255], v[60:63], v[156:159], v[240:255]
  ds_read_b64_tr_b16 v[60:61], v31 offset:38912
  ds_read_b64_tr_b16 v[62:63], v31 offset:39424
  v_cvt_pk_bf16_f32 v91, v94, v95
  v_permlane32_swap_b32 v80, v82
  v_permlane32_swap_b32 v81, v83
  buffer_store_dwordx4 v[80:83], v5, s[16:19], s69 offen offset:0 sc1
  v_permlane32_swap_b32 v88, v90
  v_permlane32_swap_b32 v89, v91
  buffer_store_dwordx4 v[88:91], v5, s[16:19], s69 offen offset:512 sc1
  s_cmp_lt_u32 s59, 26
  s_cselect_b32 s60, 0x3e8b97f6, 1.0
  v_mfma_f32_32x32x16_bf16 v[64:79], v[32:35], v[160:163], v[64:79]
  ds_read_b64_tr_b16 v[32:33], v30 offset:40960
  ds_read_b64_tr_b16 v[34:35], v30 offset:41472
  v_mul_f32 v10, s60, v26
  v_mul_f32 v96, v10, v96
  v_mul_f32 v97, v10, v97
  v_mul_f32 v98, v10, v98
  v_mul_f32 v99, v10, v99
  v_mul_f32 v100, v10, v100
  v_mul_f32 v101, v10, v101
  v_mul_f32 v102, v10, v102
  v_mfma_f32_32x32x16_bf16 v[240:255], v[36:39], v[160:163], v[240:255]
  ds_read_b64_tr_b16 v[36:37], v31 offset:40960
  ds_read_b64_tr_b16 v[38:39], v31 offset:41472
  v_mul_f32 v103, v10, v103
  v_mul_f32 v104, v10, v104
  v_mul_f32 v105, v10, v105
  v_mul_f32 v106, v10, v106
  v_mul_f32 v107, v10, v107
  v_mul_f32 v108, v10, v108
  v_mul_f32 v109, v10, v109
  v_mul_f32 v110, v10, v110
  v_mfma_f32_32x32x16_bf16 v[64:79], v[40:43], v[164:167], v[64:79]
  ds_read_b64_tr_b16 v[40:41], v30 offset:43008
  ds_read_b64_tr_b16 v[42:43], v30 offset:43520
  v_mul_f32 v111, v10, v111
  v_cvt_pk_bf16_f32 v96, v96, v97
  v_cvt_pk_bf16_f32 v97, v98, v99
  v_cvt_pk_bf16_f32 v98, v100, v101
  v_cvt_pk_bf16_f32 v99, v102, v103
  v_cvt_pk_bf16_f32 v104, v104, v105
  v_cvt_pk_bf16_f32 v105, v106, v107
  v_cvt_pk_bf16_f32 v106, v108, v109
  v_mfma_f32_32x32x16_bf16 v[240:255], v[44:47], v[164:167], v[240:255]
  ds_read_b64_tr_b16 v[44:45], v31 offset:43008
  ds_read_b64_tr_b16 v[46:47], v31 offset:43520
  v_cvt_pk_bf16_f32 v107, v110, v111
  v_permlane32_swap_b32 v96, v98
  v_permlane32_swap_b32 v97, v99
  buffer_store_dwordx4 v[96:99], v5, s[16:19], s69 offen offset:1024 sc1
  v_permlane32_swap_b32 v104, v106
  v_permlane32_swap_b32 v105, v107
  buffer_store_dwordx4 v[104:107], v5, s[16:19], s69 offen offset:1536 sc1
  s_cmp_lt_u32 s59, 24
  s_cselect_b32 s60, 0x3e8b97f6, 1.0
  s_waitcnt lgkmcnt(12)
  v_mfma_f32_32x32x16_bf16 v[64:79], v[48:51], v[168:171], v[64:79]
  ds_read_b64_tr_b16 v[48:49], v30 offset:45056
  ds_read_b64_tr_b16 v[50:51], v30 offset:45568
  v_mul_f32 v10, s60, v26
  v_mul_f32 v112, v10, v112
  v_mul_f32 v113, v10, v113
  v_mul_f32 v114, v10, v114
  v_mul_f32 v115, v10, v115
  v_mul_f32 v116, v10, v116
  v_mul_f32 v117, v10, v117
  v_mfma_f32_32x32x16_bf16 v[240:255], v[52:55], v[168:171], v[240:255]
  ds_read_b64_tr_b16 v[52:53], v31 offset:45056
  ds_read_b64_tr_b16 v[54:55], v31 offset:45568
  v_mul_f32 v118, v10, v118
  v_mul_f32 v119, v10, v119
  v_mul_f32 v120, v10, v120
  v_mul_f32 v121, v10, v121
  v_mul_f32 v122, v10, v122
  v_mul_f32 v123, v10, v123
  v_mul_f32 v124, v10, v124
  v_mul_f32 v125, v10, v125
  s_waitcnt lgkmcnt(12)
  v_mfma_f32_32x32x16_bf16 v[64:79], v[56:59], v[172:175], v[64:79]
  ds_read_b64_tr_b16 v[56:57], v30 offset:47104
  ds_read_b64_tr_b16 v[58:59], v30 offset:47616
  v_mul_f32 v126, v10, v126
  v_mul_f32 v127, v10, v127
  v_cvt_pk_bf16_f32 v112, v112, v113
  v_cvt_pk_bf16_f32 v113, v114, v115
  v_cvt_pk_bf16_f32 v114, v116, v117
  v_cvt_pk_bf16_f32 v115, v118, v119
  v_cvt_pk_bf16_f32 v120, v120, v121
  v_cvt_pk_bf16_f32 v121, v122, v123
  v_mfma_f32_32x32x16_bf16 v[240:255], v[60:63], v[172:175], v[240:255]
  ds_read_b64_tr_b16 v[60:61], v31 offset:47104
  ds_read_b64_tr_b16 v[62:63], v31 offset:47616
  v_cvt_pk_bf16_f32 v122, v124, v125
  v_cvt_pk_bf16_f32 v123, v126, v127
  v_permlane32_swap_b32 v112, v114
  v_permlane32_swap_b32 v113, v115
  buffer_store_dwordx4 v[112:115], v5, s[16:19], s69 offen offset:2048 sc1
  v_permlane32_swap_b32 v120, v122
  v_permlane32_swap_b32 v121, v123
  buffer_store_dwordx4 v[120:123], v5, s[16:19], s69 offen offset:2560 sc1
  s_barrier
  s_waitcnt lgkmcnt(12)
  v_mfma_f32_32x32x16_bf16 v[64:79], v[32:35], v[176:179], v[64:79]
  ds_read_b64_tr_b16 v[32:33], v30 offset:49152
  ds_read_b64_tr_b16 v[34:35], v30 offset:49664
  v_mfma_f32_32x32x16_bf16 v[240:255], v[36:39], v[176:179], v[240:255]
  ds_read_b64_tr_b16 v[36:37], v31 offset:49152
  ds_read_b64_tr_b16 v[38:39], v31 offset:49664
  s_waitcnt lgkmcnt(12)
  v_mfma_f32_32x32x16_bf16 v[64:79], v[40:43], v[180:183], v[64:79]
  ds_read_b64_tr_b16 v[40:41], v30 offset:51200
  ds_read_b64_tr_b16 v[42:43], v30 offset:51712
  v_mfma_f32_32x32x16_bf16 v[240:255], v[44:47], v[180:183], v[240:255]
  ds_read_b64_tr_b16 v[44:45], v31 offset:51200
  ds_read_b64_tr_b16 v[46:47], v31 offset:51712
  s_waitcnt lgkmcnt(12)
  v_mfma_f32_32x32x16_bf16 v[64:79], v[48:51], v[184:187], v[64:79]
  ds_read_b64_tr_b16 v[48:49], v30 offset:53248
  ds_read_b64_tr_b16 v[50:51], v30 offset:53760
  v_mfma_f32_32x32x16_bf16 v[240:255], v[52:55], v[184:187], v[240:255]
  ds_read_b64_tr_b16 v[52:53], v31 offset:53248
  ds_read_b64_tr_b16 v[54:55], v31 offset:53760
  s_waitcnt lgkmcnt(12)
  v_mfma_f32_32x32x16_bf16 v[64:79], v[56:59], v[188:191], v[64:79]
  ds_read_b64_tr_b16 v[56:57], v30 offset:55296
  ds_read_b64_tr_b16 v[58:59], v30 offset:55808
  v_mfma_f32_32x32x16_bf16 v[240:255], v[60:63], v[188:191], v[240:255]
  ds_read_b64_tr_b16 v[60:61], v31 offset:55296
  ds_read_b64_tr_b16 v[62:63], v31 offset:55808
  s_waitcnt lgkmcnt(12)
  v_mfma_f32_32x32x16_bf16 v[64:79], v[32:35], v[192:195], v[64:79]
  ds_read_b64_tr_b16 v[32:33], v30 offset:57344
  ds_read_b64_tr_b16 v[34:35], v30 offset:57856
  v_mfma_f32_32x32x16_bf16 v[240:255], v[36:39], v[192:195], v[240:255]
  ds_read_b64_tr_b16 v[36:37], v31 offset:57344
  ds_read_b64_tr_b16 v[38:39], v31 offset:57856
  s_waitcnt lgkmcnt(12)
  v_mfma_f32_32x32x16_bf16 v[64:79], v[40:43], v[196:199], v[64:79]
  ds_read_b64_tr_b16 v[40:41], v30 offset:59392
  ds_read_b64_tr_b16 v[42:43], v30 offset:59904
  v_mfma_f32_32x32x16_bf16 v[240:255], v[44:47], v[196:199], v[240:255]
  ds_read_b64_tr_b16 v[44:45], v31 offset:59392
  ds_read_b64_tr_b16 v[46:47], v31 offset:59904
  s_waitcnt lgkmcnt(12)
  v_mfma_f32_32x32x16_bf16 v[64:79], v[48:51], v[200:203], v[64:79]
  ds_read_b64_tr_b16 v[48:49], v30 offset:61440
  ds_read_b64_tr_b16 v[50:51], v30 offset:61952
  v_mfma_f32_32x32x16_bf16 v[240:255], v[52:55], v[200:203], v[240:255]
  ds_read_b64_tr_b16 v[52:53], v31 offset:61440
  ds_read_b64_tr_b16 v[54:55], v31 offset:61952
  s_waitcnt lgkmcnt(12)
  v_mfma_f32_32x32x16_bf16 v[64:79], v[56:59], v[204:207], v[64:79]
  ds_read_b64_tr_b16 v[56:57], v30 offset:63488
  ds_read_b64_tr_b16 v[58:59], v30 offset:64000
  v_mfma_f32_32x32x16_bf16 v[240:255], v[60:63], v[204:207], v[240:255]
  ds_read_b64_tr_b16 v[60:61], v31 offset:63488
  ds_read_b64_tr_b16 v[62:63], v31 offset:64000
  s_barrier
  s_waitcnt lgkmcnt(12)
  v_mfma_f32_32x32x16_bf16 v[64:79], v[32:35], v[208:211], v[64:79]
  ds_read_b64_tr_b16 v[32:33], v28 offset:16384
  ds_read_b64_tr_b16 v[34:35], v28 offset:16896
  v_mfma_f32_32x32x16_bf16 v[240:255], v[36:39], v[208:211], v[240:255]
  ds_read_b64_tr_b16 v[36:37], v29 offset:16384
  ds_read_b64_tr_b16 v[38:39], v29 offset:16896
  s_waitcnt lgkmcnt(12)
  v_mfma_f32_32x32x16_bf16 v[64:79], v[40:43], v[212:215], v[64:79]
  ds_read_b64_tr_b16 v[40:41], v28 offset:18432
  ds_read_b64_tr_b16 v[42:43], v28 offset:18944
  v_mfma_f32_32x32x16_bf16 v[240:255], v[44:47], v[212:215], v[240:255]
  ds_read_b64_tr_b16 v[44:45], v29 offset:18432
  ds_read_b64_tr_b16 v[46:47], v29 offset:18944
  s_waitcnt lgkmcnt(12)
  v_mfma_f32_32x32x16_bf16 v[64:79], v[48:51], v[216:219], v[64:79]
  ds_read_b64_tr_b16 v[48:49], v28 offset:20480
  ds_read_b64_tr_b16 v[50:51], v28 offset:20992
  v_mfma_f32_32x32x16_bf16 v[240:255], v[52:55], v[216:219], v[240:255]
  ds_read_b64_tr_b16 v[52:53], v29 offset:20480
  ds_read_b64_tr_b16 v[54:55], v29 offset:20992
  s_waitcnt lgkmcnt(12)
  v_mfma_f32_32x32x16_bf16 v[64:79], v[56:59], v[220:223], v[64:79]
  ds_read_b64_tr_b16 v[56:57], v28 offset:22528
  ds_read_b64_tr_b16 v[58:59], v28 offset:23040
  v_mfma_f32_32x32x16_bf16 v[240:255], v[60:63], v[220:223], v[240:255]
  ds_read_b64_tr_b16 v[60:61], v29 offset:22528
  ds_read_b64_tr_b16 v[62:63], v29 offset:23040
  s_waitcnt lgkmcnt(12)
  v_mfma_f32_32x32x16_bf16 v[64:79], v[32:35], v[224:227], v[64:79]
  ds_read_b64_tr_b16 v[32:33], v28 offset:24576
  ds_read_b64_tr_b16 v[34:35], v28 offset:25088
  v_mfma_f32_32x32x16_bf16 v[240:255], v[36:39], v[224:227], v[240:255]
  ds_read_b64_tr_b16 v[36:37], v29 offset:24576
  ds_read_b64_tr_b16 v[38:39], v29 offset:25088
  s_waitcnt lgkmcnt(12)
  v_mfma_f32_32x32x16_bf16 v[64:79], v[40:43], v[228:231], v[64:79]
  ds_read_b64_tr_b16 v[40:41], v28 offset:26624
  ds_read_b64_tr_b16 v[42:43], v28 offset:27136
  v_mfma_f32_32x32x16_bf16 v[240:255], v[44:47], v[228:231], v[240:255]
  ds_read_b64_tr_b16 v[44:45], v29 offset:26624
  ds_read_b64_tr_b16 v[46:47], v29 offset:27136
  s_waitcnt vmcnt(0)
  s_mov_b64 exec, 1
  buffer_store_dwordx2 v[6:7], off, s[44:47], s73 sc1
  s_mov_b64 exec, -1
  s_waitcnt lgkmcnt(12)
  v_mfma_f32_32x32x16_bf16 v[64:79], v[48:51], v[232:235], v[64:79]
  ds_read_b64_tr_b16 v[48:49], v28 offset:28672
  ds_read_b64_tr_b16 v[50:51], v28 offset:29184
  v_mfma_f32_32x32x16_bf16 v[240:255], v[52:55], v[232:235], v[240:255]
  ds_read_b64_tr_b16 v[52:53], v29 offset:28672
  ds_read_b64_tr_b16 v[54:55], v29 offset:29184
  s_waitcnt lgkmcnt(12)
  v_mfma_f32_32x32x16_bf16 v[64:79], v[56:59], v[236:239], v[64:79]
  ds_read_b64_tr_b16 v[56:57], v28 offset:30720
  ds_read_b64_tr_b16 v[58:59], v28 offset:31232
  v_mfma_f32_32x32x16_bf16 v[240:255], v[60:63], v[236:239], v[240:255]
  ds_read_b64_tr_b16 v[60:61], v29 offset:30720
  ds_read_b64_tr_b16 v[62:63], v29 offset:31232
  s_barrier
  s_waitcnt lgkmcnt(12)
  v_mfma_f32_32x32x16_bf16 v[80:95], v[32:35], v[128:131], 0
  ds_read_b64_tr_b16 v[32:33], v28 offset:32768
  ds_read_b64_tr_b16 v[34:35], v28 offset:33280
  ds_read_b64 v[8:9], v21 offset:0
  v_mfma_f32_32x32x16_bf16 v[96:111], v[36:39], v[128:131], 0
  ds_read_b64_tr_b16 v[36:37], v29 offset:32768
  ds_read_b64_tr_b16 v[38:39], v29 offset:33280
  s_waitcnt lgkmcnt(2)
  v_mfma_f32_32x32x8_bf16 v[64:79], v[8:9], v[24:25], v[64:79]
  v_mfma_f32_32x32x16_bf16 v[80:95], v[40:43], v[132:135], v[80:95]
  ds_read_b64_tr_b16 v[40:41], v28 offset:34816
  ds_read_b64_tr_b16 v[42:43], v28 offset:35328
  ds_read_b64 v[8:9], v21 offset:256
  v_mfma_f32_32x32x16_bf16 v[96:111], v[44:47], v[132:135], v[96:111]
  ds_read_b64_tr_b16 v[44:45], v29 offset:34816
  ds_read_b64_tr_b16 v[46:47], v29 offset:35328
  s_waitcnt lgkmcnt(2)
  v_mfma_f32_32x32x8_bf16 v[240:255], v[8:9], v[24:25], v[240:255]
  v_mfma_f32_32x32x16_bf16 v[80:95], v[48:51], v[136:139], v[80:95]
  ds_read_b64_tr_b16 v[48:49], v28 offset:36864
  ds_read_b64_tr_b16 v[50:51], v28 offset:37376
  v_mfma_f32_32x32x16_bf16 v[96:111], v[52:55], v[136:139], v[96:111]
  ds_read_b64_tr_b16 v[52:53], v29 offset:36864
  ds_read_b64_tr_b16 v[54:55], v29 offset:37376
  v_max_f32 v112, 0, v64
  v_max_f32 v113, 0, v65
  v_max_f32 v114, 0, v66
  v_mfma_f32_32x32x16_bf16 v[80:95], v[56:59], v[140:143], v[80:95]
  ds_read_b64_tr_b16 v[56:57], v28 offset:38912
  ds_read_b64_tr_b16 v[58:59], v28 offset:39424
  v_max_f32 v115, 0, v67
  v_max_f32 v116, 0, v68
  v_max_f32 v117, 0, v69
  v_mfma_f32_32x32x16_bf16 v[96:111], v[60:63], v[140:143], v[96:111]
  ds_read_b64_tr_b16 v[60:61], v29 offset:38912
  ds_read_b64_tr_b16 v[62:63], v29 offset:39424
  v_max_f32 v118, 0, v70
  v_max_f32 v119, 0, v71
  v_mul_f32 v64, v27, v64
  v_mfma_f32_32x32x16_bf16 v[80:95], v[32:35], v[144:147], v[80:95]
  ds_read_b64_tr_b16 v[32:33], v28 offset:40960
  ds_read_b64_tr_b16 v[34:35], v28 offset:41472
  v_mul_f32 v65, v27, v65
  v_mul_f32 v66, v27, v66
  v_mul_f32 v67, v27, v67
  v_mfma_f32_32x32x16_bf16 v[96:111], v[36:39], v[144:147], v[96:111]
  ds_read_b64_tr_b16 v[36:37], v29 offset:40960
  ds_read_b64_tr_b16 v[38:39], v29 offset:41472
  v_mul_f32 v68, v27, v68
  v_mul_f32 v69, v27, v69
  v_mul_f32 v70, v27, v70
  s_waitcnt lgkmcnt(12)
  v_mfma_f32_32x32x16_bf16 v[80:95], v[40:43], v[148:151], v[80:95]
  ds_read_b64_tr_b16 v[40:41], v28 offset:43008
  ds_read_b64_tr_b16 v[42:43], v28 offset:43520
  v_mul_f32 v71, v27, v71
  v_mul_f32 v64, v112, v64
  v_mul_f32 v65, v113, v65
  v_mfma_f32_32x32x16_bf16 v[96:111], v[44:47], v[148:151], v[96:111]
  ds_read_b64_tr_b16 v[44:45], v29 offset:43008
  ds_read_b64_tr_b16 v[46:47], v29 offset:43520
  v_mul_f32 v66, v114, v66
  v_mul_f32 v67, v115, v67
  v_mul_f32 v68, v116, v68
  s_waitcnt lgkmcnt(12)
  v_mfma_f32_32x32x16_bf16 v[80:95], v[48:51], v[152:155], v[80:95]
  ds_read_b64_tr_b16 v[48:49], v28 offset:45056
  ds_read_b64_tr_b16 v[50:51], v28 offset:45568
  v_mul_f32 v69, v117, v69
  v_mul_f32 v70, v118, v70
  v_mfma_f32_32x32x16_bf16 v[96:111], v[52:55], v[152:155], v[96:111]
  ds_read_b64_tr_b16 v[52:53], v29 offset:45056
  ds_read_b64_tr_b16 v[54:55], v29 offset:45568
  v_mul_f32 v71, v119, v71
  v_max_f32 v112, 0, v72
  v_max_f32 v113, 0, v73
  s_waitcnt lgkmcnt(12)
  v_mfma_f32_32x32x16_bf16 v[80:95], v[56:59], v[156:159], v[80:95]
  ds_read_b64_tr_b16 v[56:57], v28 offset:47104
  ds_read_b64_tr_b16 v[58:59], v28 offset:47616
  v_max_f32 v114, 0, v74
  v_max_f32 v115, 0, v75
  v_max_f32 v116, 0, v76
  v_mfma_f32_32x32x16_bf16 v[96:111], v[60:63], v[156:159], v[96:111]
  ds_read_b64_tr_b16 v[60:61], v29 offset:47104
  ds_read_b64_tr_b16 v[62:63], v29 offset:47616
  v_max_f32 v117, 0, v77
  v_max_f32 v118, 0, v78
  v_max_f32 v119, 0, v79
  s_waitcnt lgkmcnt(0)
  s_barrier
  v_mfma_f32_32x32x16_bf16 v[80:95], v[32:35], v[160:163], v[80:95]
  ds_read_b64_tr_b16 v[32:33], v28 offset:0
  ds_read_b64_tr_b16 v[34:35], v28 offset:512
  v_mul_f32 v72, v27, v72
  v_mul_f32 v73, v27, v73
  v_mul_f32 v74, v27, v74
  v_mfma_f32_32x32x16_bf16 v[96:111], v[36:39], v[160:163], v[96:111]
  ds_read_b64_tr_b16 v[36:37], v29 offset:0
  ds_read_b64_tr_b16 v[38:39], v29 offset:512
  v_mul_f32 v75, v27, v75
  v_mul_f32 v76, v27, v76
  v_mul_f32 v77, v27, v77
  v_mul_f32 v78, v27, v78
  v_mfma_f32_32x32x16_bf16 v[80:95], v[40:43], v[164:167], v[80:95]
  ds_read_b64_tr_b16 v[40:41], v28 offset:2048
  ds_read_b64_tr_b16 v[42:43], v28 offset:2560
  v_mul_f32 v79, v27, v79
  v_mul_f32 v72, v112, v72
  v_mul_f32 v73, v113, v73
  v_mul_f32 v74, v114, v74
  v_mfma_f32_32x32x16_bf16 v[96:111], v[44:47], v[164:167], v[96:111]
  ds_read_b64_tr_b16 v[44:45], v29 offset:2048
  ds_read_b64_tr_b16 v[46:47], v29 offset:2560
  v_mul_f32 v75, v115, v75
  ds_read_b64_tr_b16 v[128:129], v14 offset:0
  ds_read_b64_tr_b16 v[130:131], v14 offset:512
  ds_read_b64_tr_b16 v[132:133], v15 offset:0
  v_mfma_f32_32x32x16_bf16 v[80:95], v[48:51], v[168:171], v[80:95]
  ds_read_b64_tr_b16 v[48:49], v28 offset:4096
  ds_read_b64_tr_b16 v[50:51], v28 offset:4608
  v_mul_f32 v76, v116, v76
  v_mul_f32 v77, v117, v77
  v_mul_f32 v78, v118, v78
  v_mfma_f32_32x32x16_bf16 v[96:111], v[52:55], v[168:171], v[96:111]
  ds_read_b64_tr_b16 v[52:53], v29 offset:4096
  ds_read_b64_tr_b16 v[54:55], v29 offset:4608
  v_mul_f32 v79, v119, v79
  v_cvt_pk_bf16_f32 v64, v64, v65
  v_cvt_pk_bf16_f32 v65, v66, v67
  v_cvt_pk_bf16_f32 v66, v68, v69
  v_mfma_f32_32x32x16_bf16 v[80:95], v[56:59], v[172:175], v[80:95]
  ds_read_b64_tr_b16 v[56:57], v28 offset:6144
  ds_read_b64_tr_b16 v[58:59], v28 offset:6656
  v_cvt_pk_bf16_f32 v67, v70, v71
  v_cvt_pk_bf16_f32 v72, v72, v73
  v_cvt_pk_bf16_f32 v73, v74, v75
  v_mfma_f32_32x32x16_bf16 v[96:111], v[60:63], v[172:175], v[96:111]
  ds_read_b64_tr_b16 v[60:61], v29 offset:6144
  ds_read_b64_tr_b16 v[62:63], v29 offset:6656
  v_cvt_pk_bf16_f32 v74, v76, v77
  ds_read_b64_tr_b16 v[134:135], v15 offset:512
  ds_read_b64_tr_b16 v[136:137], v16 offset:0
  ds_read_b64_tr_b16 v[138:139], v16 offset:512
  s_waitcnt lgkmcnt(15)
  v_mfma_f32_32x32x16_bf16 v[80:95], v[32:35], v[176:179], v[80:95]
  ds_read_b64_tr_b16 v[32:33], v28 offset:8192
  ds_read_b64_tr_b16 v[34:35], v28 offset:8704
  v_cvt_pk_bf16_f32 v75, v78, v79
  v_permlane32_swap_b32 v64, v66
  v_permlane32_swap_b32 v65, v67
  v_mfma_f32_32x32x16_bf16 v[96:111], v[36:39], v[176:179], v[96:111]
  ds_read_b64_tr_b16 v[36:37], v29 offset:8192
  ds_read_b64_tr_b16 v[38:39], v29 offset:8704
  buffer_store_dwordx4 v[64:67], v0, s[28:31], s70 offen offset:0 sc1
  v_permlane32_swap_b32 v72, v74
  v_permlane32_swap_b32 v73, v75
  buffer_store_dwordx4 v[72:75], v0, s[28:31], s70 offen offset:512 sc1
  s_waitcnt lgkmcnt(15)
  v_mfma_f32_32x32x16_bf16 v[80:95], v[40:43], v[180:183], v[80:95]
  ds_read_b64_tr_b16 v[40:41], v28 offset:10240
  ds_read_b64_tr_b16 v[42:43], v28 offset:10752
  v_max_f32 v112, 0, v240
  v_max_f32 v113, 0, v241
  v_max_f32 v114, 0, v242
  v_mfma_f32_32x32x16_bf16 v[96:111], v[44:47], v[180:183], v[96:111]
  ds_read_b64_tr_b16 v[44:45], v29 offset:10240
  ds_read_b64_tr_b16 v[46:47], v29 offset:10752
  v_max_f32 v115, 0, v243
  v_max_f32 v116, 0, v244
  ds_read_b64_tr_b16 v[140:141], v17 offset:0
  ds_read_b64_tr_b16 v[142:143], v17 offset:512
  s_waitcnt lgkmcnt(15)
  v_mfma_f32_32x32x16_bf16 v[80:95], v[48:51], v[184:187], v[80:95]
  ds_read_b64_tr_b16 v[48:49], v28 offset:12288
  ds_read_b64_tr_b16 v[50:51], v28 offset:12800
  v_max_f32 v117, 0, v245
  v_max_f32 v118, 0, v246
  v_max_f32 v119, 0, v247
  v_mfma_f32_32x32x16_bf16 v[96:111], v[52:55], v[184:187], v[96:111]
  ds_read_b64_tr_b16 v[52:53], v29 offset:12288
  ds_read_b64_tr_b16 v[54:55], v29 offset:12800
  v_mul_f32 v240, v27, v240
  v_mul_f32 v241, v27, v241
  v_mul_f32 v242, v27, v242
  s_waitcnt lgkmcnt(15)
  v_mfma_f32_32x32x16_bf16 v[80:95], v[56:59], v[188:191], v[80:95]
  ds_read_b64_tr_b16 v[56:57], v28 offset:14336
  ds_read_b64_tr_b16 v[58:59], v28 offset:14848
  v_mul_f32 v243, v27, v243
  v_mul_f32 v244, v27, v244
  v_mul_f32 v245, v27, v245
  v_mfma_f32_32x32x16_bf16 v[96:111], v[60:63], v[188:191], v[96:111]
  ds_read_b64_tr_b16 v[60:61], v29 offset:14336
  ds_read_b64_tr_b16 v[62:63], v29 offset:14848
  v_mul_f32 v246, v27, v246
  v_mul_f32 v247, v27, v247
  v_subrev_u32 v30, 16384, v30
  v_subrev_u32 v31, 16384, v31
  s_waitcnt lgkmcnt(0)
  s_barrier
  v_mfma_f32_32x32x16_bf16 v[80:95], v[32:35], v[192:195], v[80:95]
  ds_read_b64_tr_b16 v[32:33], v30 offset:0
  ds_read_b64_tr_b16 v[34:35], v30 offset:512
  buffer_load_dwordx4 v[120:123], v4, s[16:19], s101 offen sc1
  v_mul_f32 v240, v112, v240
  v_mul_f32 v241, v113, v241
  v_mfma_f32_32x32x16_bf16 v[96:111], v[36:39], v[192:195], v[96:111]
  ds_read_b64_tr_b16 v[36:37], v31 offset:0
  ds_read_b64_tr_b16 v[38:39], v31 offset:512
  v_mul_f32 v242, v114, v242
  v_mul_f32 v243, v115, v243
  v_mul_f32 v244, v116, v244
  v_mfma_f32_32x32x16_bf16 v[80:95], v[40:43], v[196:199], v[80:95]
  ds_read_b64_tr_b16 v[40:41], v30 offset:2048
  ds_read_b64_tr_b16 v[42:43], v30 offset:2560
  v_mul_f32 v245, v117, v245
  v_mul_f32 v246, v118, v246
  v_mul_f32 v247, v119, v247
  v_mfma_f32_32x32x16_bf16 v[96:111], v[44:47], v[196:199], v[96:111]
  ds_read_b64_tr_b16 v[44:45], v31 offset:2048
  ds_read_b64_tr_b16 v[46:47], v31 offset:2560
  v_max_f32 v112, 0, v248
  v_max_f32 v113, 0, v249
  v_max_f32 v114, 0, v250
  v_max_f32 v115, 0, v251
  v_mfma_f32_32x32x16_bf16 v[80:95], v[48:51], v[200:203], v[80:95]
  ds_read_b64_tr_b16 v[48:49], v30 offset:4096
  ds_read_b64_tr_b16 v[50:51], v30 offset:4608
  v_max_f32 v116, 0, v252
  v_max_f32 v117, 0, v253
  v_mfma_f32_32x32x16_bf16 v[96:111], v[52:55], v[200:203], v[96:111]
  ds_read_b64_tr_b16 v[52:53], v31 offset:4096
  ds_read_b64_tr_b16 v[54:55], v31 offset:4608
  v_max_f32 v118, 0, v254
  v_max_f32 v119, 0, v255
  v_mul_f32 v248, v27, v248
  v_mfma_f32_32x32x16_bf16 v[80:95], v[56:59], v[204:207], v[80:95]
  ds_read_b64_tr_b16 v[56:57], v30 offset:6144
  ds_read_b64_tr_b16 v[58:59], v30 offset:6656
  v_mul_f32 v249, v27, v249
  v_mul_f32 v250, v27, v250
  v_mul_f32 v251, v27, v251
  v_mfma_f32_32x32x16_bf16 v[96:111], v[60:63], v[204:207], v[96:111]
  ds_read_b64_tr_b16 v[60:61], v31 offset:6144
  ds_read_b64_tr_b16 v[62:63], v31 offset:6656
  v_mul_f32 v252, v27, v252
  v_mul_f32 v253, v27, v253
  v_mul_f32 v254, v27, v254
  s_waitcnt lgkmcnt(12)
  v_mfma_f32_32x32x16_bf16 v[80:95], v[32:35], v[208:211], v[80:95]
  ds_read_b64_tr_b16 v[32:33], v30 offset:8192
  ds_read_b64_tr_b16 v[34:35], v30 offset:8704
  v_mul_f32 v255, v27, v255
  v_mul_f32 v248, v112, v248
  v_mul_f32 v249, v113, v249
  v_mfma_f32_32x32x16_bf16 v[96:111], v[36:39], v[208:211], v[96:111]
  ds_read_b64_tr_b16 v[36:37], v31 offset:8192
  ds_read_b64_tr_b16 v[38:39], v31 offset:8704
  v_mul_f32 v250, v114, v250
  v_mul_f32 v251, v115, v251
  v_mul_f32 v252, v116, v252
  s_waitcnt lgkmcnt(12)
  v_mfma_f32_32x32x16_bf16 v[80:95], v[40:43], v[212:215], v[80:95]
  ds_read_b64_tr_b16 v[40:41], v30 offset:10240
  ds_read_b64_tr_b16 v[42:43], v30 offset:10752
  v_mul_f32 v253, v117, v253
  v_mul_f32 v254, v118, v254
  v_mul_f32 v255, v119, v255
  v_mfma_f32_32x32x16_bf16 v[96:111], v[44:47], v[212:215], v[96:111]
  ds_read_b64_tr_b16 v[44:45], v31 offset:10240
  ds_read_b64_tr_b16 v[46:47], v31 offset:10752
  v_cvt_pk_bf16_f32 v240, v240, v241
  v_cvt_pk_bf16_f32 v241, v242, v243
  v_cvt_pk_bf16_f32 v242, v244, v245
  s_waitcnt lgkmcnt(12)
  v_mfma_f32_32x32x16_bf16 v[80:95], v[48:51], v[216:219], v[80:95]
  ds_read_b64_tr_b16 v[48:49], v30 offset:12288
  ds_read_b64_tr_b16 v[50:51], v30 offset:12800
  v_cvt_pk_bf16_f32 v243, v246, v247
  v_cvt_pk_bf16_f32 v248, v248, v249
  v_mfma_f32_32x32x16_bf16 v[96:111], v[52:55], v[216:219], v[96:111]
  ds_read_b64_tr_b16 v[52:53], v31 offset:12288
  ds_read_b64_tr_b16 v[54:55], v31 offset:12800
  v_cvt_pk_bf16_f32 v249, v250, v251
  v_cvt_pk_bf16_f32 v250, v252, v253
  v_cvt_pk_bf16_f32 v251, v254, v255
  s_waitcnt lgkmcnt(12)
  v_mfma_f32_32x32x16_bf16 v[80:95], v[56:59], v[220:223], v[80:95]
  ds_read_b64_tr_b16 v[56:57], v30 offset:14336
  ds_read_b64_tr_b16 v[58:59], v30 offset:14848
  v_permlane32_swap_b32 v240, v242
  v_permlane32_swap_b32 v241, v243
  buffer_store_dwordx4 v[240:243], v0, s[28:31], s70 offen offset:1024 sc1
  v_mfma_f32_32x32x16_bf16 v[96:111], v[60:63], v[220:223], v[96:111]
  ds_read_b64_tr_b16 v[60:61], v31 offset:14336
  ds_read_b64_tr_b16 v[62:63], v31 offset:14848
  v_permlane32_swap_b32 v248, v250
  v_permlane32_swap_b32 v249, v251
  buffer_store_dwordx4 v[248:251], v0, s[28:31], s70 offen offset:1536 sc1
  s_waitcnt lgkmcnt(12)
  v_mfma_f32_32x32x16_bf16 v[80:95], v[32:35], v[224:227], v[80:95]
  ds_read_b64_tr_b16 v[144:145], v14 offset:32768
  v_mfma_f32_32x32x16_bf16 v[96:111], v[36:39], v[224:227], v[96:111]
  ds_read_b64_tr_b16 v[146:147], v14 offset:33280
  s_waitcnt lgkmcnt(10)
  v_mfma_f32_32x32x16_bf16 v[80:95], v[40:43], v[228:231], v[80:95]
  ds_read_b64_tr_b16 v[148:149], v15 offset:32768
  v_mfma_f32_32x32x16_bf16 v[96:111], v[44:47], v[228:231], v[96:111]
  ds_read_b64_tr_b16 v[150:151], v15 offset:33280
  s_waitcnt lgkmcnt(8)
  v_mfma_f32_32x32x16_bf16 v[80:95], v[48:51], v[232:235], v[80:95]
  ds_read_b64_tr_b16 v[152:153], v16 offset:32768
  v_mfma_f32_32x32x16_bf16 v[96:111], v[52:55], v[232:235], v[96:111]
  ds_read_b64_tr_b16 v[154:155], v16 offset:33280
  s_waitcnt lgkmcnt(6)
  v_mfma_f32_32x32x16_bf16 v[80:95], v[56:59], v[236:239], v[80:95]
  ds_read_b64_tr_b16 v[156:157], v17 offset:32768
  v_mfma_f32_32x32x16_bf16 v[96:111], v[60:63], v[236:239], v[96:111]
  ds_read_b64_tr_b16 v[158:159], v17 offset:33280
  s_waitcnt lgkmcnt(0)
  s_barrier
  ds_read_b64 v[8:9], v21 offset:512
  s_waitcnt lgkmcnt(0)
  v_mfma_f32_32x32x8_bf16 v[80:95], v[8:9], v[24:25], v[80:95]
  ds_read_b64 v[8:9], v21 offset:768
  s_waitcnt lgkmcnt(0)
  v_mfma_f32_32x32x8_bf16 v[96:111], v[8:9], v[24:25], v[96:111]
  s_nop 8
  v_max_f32 v112, 0, v80
  v_max_f32 v113, 0, v81
  v_max_f32 v114, 0, v82
  v_max_f32 v115, 0, v83
  v_max_f32 v116, 0, v84
  v_max_f32 v117, 0, v85
  v_max_f32 v118, 0, v86
  v_max_f32 v119, 0, v87
  v_mul_f32 v80, v27, v80
  v_mul_f32 v81, v27, v81
  v_mul_f32 v82, v27, v82
  v_mul_f32 v83, v27, v83
  v_mul_f32 v84, v27, v84
  v_mul_f32 v85, v27, v85
  v_mul_f32 v86, v27, v86
  v_mul_f32 v87, v27, v87
  v_mul_f32 v80, v112, v80
  v_mul_f32 v81, v113, v81
  v_mul_f32 v82, v114, v82
  v_mul_f32 v83, v115, v83
  v_mul_f32 v84, v116, v84
  v_mul_f32 v85, v117, v85
  v_mul_f32 v86, v118, v86
  v_mul_f32 v87, v119, v87
  v_max_f32 v112, 0, v88
  v_max_f32 v113, 0, v89
  v_max_f32 v114, 0, v90
  v_max_f32 v115, 0, v91
  v_max_f32 v116, 0, v92
  v_max_f32 v117, 0, v93
  v_max_f32 v118, 0, v94
  v_max_f32 v119, 0, v95
  v_mul_f32 v88, v27, v88
  v_mul_f32 v89, v27, v89
  v_mul_f32 v90, v27, v90
  v_mul_f32 v91, v27, v91
  v_mul_f32 v92, v27, v92
  v_mul_f32 v93, v27, v93
  v_mul_f32 v94, v27, v94
  v_mul_f32 v95, v27, v95
  v_mul_f32 v88, v112, v88
  v_mul_f32 v89, v113, v89
  v_mul_f32 v90, v114, v90
  v_mul_f32 v91, v115, v91
  v_mul_f32 v92, v116, v92
  v_mul_f32 v93, v117, v93
  v_mul_f32 v94, v118, v94
  v_mul_f32 v95, v119, v95
  v_cvt_pk_bf16_f32 v80, v80, v81
  v_cvt_pk_bf16_f32 v81, v82, v83
  v_cvt_pk_bf16_f32 v82, v84, v85
  v_cvt_pk_bf16_f32 v83, v86, v87
  v_cvt_pk_bf16_f32 v88, v88, v89
  v_cvt_pk_bf16_f32 v89, v90, v91
  v_cvt_pk_bf16_f32 v90, v92, v93
  v_cvt_pk_bf16_f32 v91, v94, v95
  v_permlane32_swap_b32 v80, v82
  v_permlane32_swap_b32 v81, v83
  buffer_store_dwordx4 v[80:83], v0, s[28:31], s70 offen offset:2048 sc1
  v_permlane32_swap_b32 v88, v90
  v_permlane32_swap_b32 v89, v91
  buffer_store_dwordx4 v[88:91], v0, s[28:31], s70 offen offset:2560 sc1
  v_max_f32 v112, 0, v96
  v_max_f32 v113, 0, v97
  v_max_f32 v114, 0, v98
  v_max_f32 v115, 0, v99
  v_max_f32 v116, 0, v100
  v_max_f32 v117, 0, v101
  v_max_f32 v118, 0, v102
  v_max_f32 v119, 0, v103
  v_mul_f32 v96, v27, v96
  v_mul_f32 v97, v27, v97
  v_mul_f32 v98, v27, v98
  v_mul_f32 v99, v27, v99
  v_mul_f32 v100, v27, v100
  v_mul_f32 v101, v27, v101
  v_mul_f32 v102, v27, v102
  v_mul_f32 v103, v27, v103
  v_mul_f32 v96, v112, v96
  v_mul_f32 v97, v113, v97
  v_mul_f32 v98, v114, v98
  v_mul_f32 v99, v115, v99
  v_mul_f32 v100, v116, v100
  v_mul_f32 v101, v117, v101
  v_mul_f32 v102, v118, v102
  v_mul_f32 v103, v119, v103
  v_max_f32 v112, 0, v104
  v_max_f32 v113, 0, v105
  v_max_f32 v114, 0, v106
  v_max_f32 v115, 0, v107
  v_max_f32 v116, 0, v108
  v_max_f32 v117, 0, v109
  v_max_f32 v118, 0, v110
  v_max_f32 v119, 0, v111
  v_mul_f32 v104, v27, v104
  v_mul_f32 v105, v27, v105
  v_mul_f32 v106, v27, v106
  v_mul_f32 v107, v27, v107
  v_mul_f32 v108, v27, v108
  v_mul_f32 v109, v27, v109
  v_mul_f32 v110, v27, v110
  v_mul_f32 v111, v27, v111
  v_mul_f32 v104, v112, v104
  v_mul_f32 v105, v113, v105
  v_mul_f32 v106, v114, v106
  v_mul_f32 v107, v115, v107
  v_mul_f32 v108, v116, v108
  v_mul_f32 v109, v117, v109
  v_mul_f32 v110, v118, v110
  v_mul_f32 v111, v119, v111
  v_cvt_pk_bf16_f32 v96, v96, v97
  v_cvt_pk_bf16_f32 v97, v98, v99
  v_cvt_pk_bf16_f32 v98, v100, v101
  v_cvt_pk_bf16_f32 v99, v102, v103
  v_cvt_pk_bf16_f32 v104, v104, v105
  v_cvt_pk_bf16_f32 v105, v106, v107
  v_cvt_pk_bf16_f32 v106, v108, v109
  v_cvt_pk_bf16_f32 v107, v110, v111
  v_permlane32_swap_b32 v96, v98
  v_permlane32_swap_b32 v97, v99
  buffer_store_dwordx4 v[96:99], v0, s[28:31], s70 offen offset:3072 sc1
  v_permlane32_swap_b32 v104, v106
  v_permlane32_swap_b32 v105, v107
  buffer_store_dwordx4 v[104:107], v0, s[28:31], s70 offen offset:3584 sc1
  s_branch L_att
L_spare:
  s_lshl_b32 s64, s52, 11
  v_lshlrev_b32 v4, 4, v1
  s_lshl_b32 s65, s52, 10
  v_bfe_u32 v32, v1, 1, 2
  s_add_u32 s44, s16, 0x1000000
  s_addc_u32 s45, s17, 0
  v_and_b32 v9, 1, v3
  s_mov_b32 s14, 0x188000
  v_xor_b32 v32, v32, v9
  s_mov_b32 s15, 0x20000
  v_lshlrev_b32 v32, 5, v32
  s_mov_b32 s50, 0x62000
  v_and_b32 v8, 1, v1
  s_mov_b32 s51, 0x20000
  v_lshl_add_u32 v32, v8, 4, v32
  s_mov_b32 s26, 0x188000
  v_lshrrev_b32 v33, 3, v1
  s_mov_b32 s27, 0x20000
  v_mul_u32_u24 v12, 896, v33
  s_mov_b32 s42, 0x380
  v_add_u32 v12, v12, v32
  s_mov_b32 s43, 0x20000
  v_xor_b32 v13, 64, v12
  s_mov_b32 s34, 0x1c0000
  v_lshlrev_b32 v8, 7, v9
  s_mov_b32 s35, 0x20000
  v_xor_b32 v21, v4, v8
  s_mov_b32 s18, 0x540000
  v_add_u32 v21, 14336, v21
  s_mov_b32 s19, 0x20000
  v_lshrrev_b32 v8, 1, v3
  s_mov_b32 s46, 0x100000
  v_mul_u32_u24 v10, 3584, v8
  s_mov_b32 s47, 0x20000
  v_sub_u32 v20, v13, v10
  s_mov_b32 s22, 0x100
  v_add_u32 v20, 2560, v20
  s_mov_b32 s23, 0x20000
  v_mul_u32_u24 v10, 10752, v8
  s_and_b32 s79, s58, 1
  v_add_u32 v18, v12, v10
  s_lshl1_add_u32 s76, s57, s79
  v_add_u32 v19, v13, v10
  s_lshr_b32 s77, s58, 1
  v_add_u32 v19, 2560, v19
  s_mul_i32 s78, s76, 7
  v_add_u32 v13, 6144, v13
  s_lshr_b32 s78, s78, 1
  v_bfe_u32 v34, v1, 2, 2
  s_lshl3_add_u32 s60, s77, s52
  v_lshlrev_b32 v34, 7, v34
  s_mul_i32 s61, s53, 6
  v_and_b32 v10, 3, v1
  s_lshl3_add_u32 s61, s77, s61
  v_lshl_add_u32 v34, v10, 3, v34
  s_sub_i32 s72, s61, 16
  v_bfe_u32 v10, v1, 3, 2
  s_lshl2_add_u32 s61, s77, s53
  v_lshl_or_b32 v34, v10, 5, v34
  s_add_u32 s59, s65, 40960
  v_lshl_add_u32 v9, v9, 10, v34
  s_add_u32 s62, s65, 16384
  v_lshl_add_u32 v9, v8, 14, v9
  v_add_u32 v14, s64, v9
  v_add_u32 v14, 81920, v14
  v_xor_b32 v15, 32, v14
  v_xor_b32 v16, 64, v14
  v_xor_b32 v17, 96, v14
  v_add_u32 v22, s59, v4
  s_sub_i32 s80, 16, s60
  v_lshrrev_b32 v8, 2, v1
  s_mul_i32 s101, s60, 168
  v_and_b32 v9, 3, v1
  s_add_u32 s101, s101, s78
  v_add_u32 v9, s79, v9
  s_lshl_b32 s101, s101, 8
  v_lshrrev_b32 v10, 1, v9
  s_mul_i32 s39, s60, 72
  v_and_b32 v23, 1, v10
  s_add_u32 s39, s39, s76
  v_lshlrev_b32 v23, 3, v23
  s_add_u32 s39, s39, 56
  v_xor_b32 v23, v23, v8
  s_lshl_b32 s39, s39, 10
  v_lshlrev_b32 v23, 4, v23
  s_add_u32 s85, s78, 56
  v_lshl_add_u32 v23, v10, 8, v23
  s_lshl_b32 s85, s85, 8
  v_and_b32 v10, 1, v9
  s_and_b32 s66, s58, 3
  v_lshl_add_u32 v23, v10, 3, v23
  s_lshl2_add_u32 s81, s57, s66
  v_add_u32 v23, s62, v23
  s_lshr_b32 s82, s58, 2
  v_bfe_u32 v8, v1, 1, 2
  s_min_u32 s82, s82, 6
  v_min_u32 v8, 2, v8
  s_lshl_b32 s66, s82, 7
  v_lshl_add_u32 v8, v8, 1, s72
  s_mul_i32 s83, s52, 200704
  v_max_i32 v8, 0, v8
  s_add_u32 s83, s83, s66
  v_lshrrev_b32 v8, 1, v8
  s_mul_i32 s84, s52, 50176
  v_min_u32 v9, 2, v3
  s_add_u32 s84, s84, s66
  v_mov_b32 v10, s61
  s_lshl1_add_u32 s66, s77, s54
  v_cmp_eq_u32 vcc, 0, v9
  s_lshl4_add_u32 s66, s66, s76
  v_mul_u32_u24 v9, 56, v9
  s_lshl2_add_u32 s66, s66, s53
  v_cndmask_b32 v8, v8, v10, vcc
  s_lshl3_add_u32 s75, s66, 524288
  v_and_b32 v10, 1, v1
  v_mul_u32_u24 v10, 3, v10
  v_add3_u32 v9, v9, v10, s78
  v_mul_u32_u24 v9, 171, v9
  v_lshrrev_b32 v9, 11, v9
  v_lshl_add_u32 v8, v8, 4, v9
  v_lshlrev_b32 v5, 6, v8
  s_add_u32 s28, s16, 0x600000
  s_addc_u32 s29, s17, 0
  s_mov_b32 s30, 0x900000
  s_mov_b32 s31, 0x20000
  s_sub_u32 s59, s58, 28
  s_lshl3_add_u32 s59, s59, s52
  s_lshl3_add_u32 s62, s59, s57
  v_min_u32 v9, 48, v1
  v_lshlrev_b32 v9, 7, v9
  v_min_u32 v8, 55, v1
  v_lshlrev_b32 v8, 7, v8
  v_min_u32 v10, 12, v1
  v_lshlrev_b32 v10, 7, v10
  s_mul_i32 s60, s62, 6272
  s_mul_i32 s61, s62, 1568
  v_bfe_u32 v70, v1, 2, 2
  v_min_u32 v70, 2, v70
  v_lshlrev_b32 v70, 18, v70
  v_and_b32 v71, 3, v1
  v_lshl_add_u32 v70, v71, 7, v70
  s_lshl_b32 s66, s62, 9
  buffer_load_dword v71, v70, s[44:47], s66 offen nt
  s_waitcnt vmcnt(0)
  buffer_load_dword v64, v9, s[12:15], s60 offen
  s_barrier
  buffer_load_dword v65, v9, s[24:27], s60 offen
  buffer_load_dword v66, v10, s[48:51], s61 offen
  s_barrier
  v_min_u32 v10, 13, v2
  v_lshlrev_b32 v10, 7, v10
  v_mul_u32_u24 v67, 3584, v3
  v_add_u32 v10, v67, v10
  s_and_b32 s60, s57, 1
  s_mul_i32 s60, s60, 1792
  s_mul_i32 s61, s59, 14336
  s_add_u32 s60, s60, s61
  v_add_u32 v10, s60, v10
  s_lshr_b32 s60, s59, 2
  s_mul_i32 s60, s60, 200704
  s_mul_i32 s61, s53, 7168
  s_add_u32 s60, s60, s61
  buffer_load_dword v68, v10, s[12:15], 0 offen
  v_add_u32 v10, 458752, v10
  s_barrier
  buffer_load_dword v69, v10, s[12:15], 0 offen
  v_add_u32 v10, 458752, v10
  s_barrier
  buffer_load_dword v70, v10, s[12:15], 0 offen
  v_add_u32 v10, 458752, v10
  s_barrier
  buffer_load_dword v71, v10, s[12:15], 0 offen
  v_add_u32 v10, 458752, v10
  s_barrier
  buffer_load_dword v72, v8, s[24:27], s60 offen
  s_add_u32 s60, s60, 28672
  s_barrier
  buffer_load_dword v73, v8, s[24:27], s60 offen
  s_add_u32 s60, s60, 28672
  s_barrier
  buffer_load_dword v74, v8, s[24:27], s60 offen
  s_add_u32 s60, s60, 28672
  s_barrier
  buffer_load_dword v75, v8, s[24:27], s60 offen
  s_add_u32 s60, s60, 28672
  s_barrier
  s_mov_b32 s83, s60
  s_mov_b32 s26, 0
  s_mov_b32 s63, 0
Lpoll_5:
  buffer_load_dwordx2 v[6:7], off, s[20:23], 0 sc1
  s_waitcnt vmcnt(0)
  v_cmp_eq_u32 vcc, 0, v6
  s_add_u32 s63, s63, 1
  s_nop 0
  s_cmp_eq_u64 vcc, 0
  s_cbranch_scc1 Lok_6
  s_cmp_lt_u32 s63, 100000
  s_sleep 16
  s_cbranch_scc1 Lpoll_5
Lok_6:
  s_cmp_eq_u32 s54, 0
  s_cbranch_scc1 L_sp1
  s_mov_b32 s63, 0
Lpoll_7:
  buffer_load_dwordx2 v[114:115], v5, s[44:47], 0 offen sc1
  s_waitcnt vmcnt(0)
  v_cmp_ne_u64 vcc, v[114:115], v[6:7]
  s_add_u32 s63, s63, 1
  s_nop 0
  s_cmp_eq_u64 vcc, 0
  s_cbranch_scc1 Lok_8
  s_cmp_lt_u32 s63, 100000
  s_sleep 16
  s_cbranch_scc1 Lpoll_7
Lok_8:
  s_mul_i32 s63, s53, 6144
  s_add_u32 m0, s63, 40960
  s_add_i32 s66, s72, 0
  s_max_i32 s66, s66, 0
  s_mul_i32 s66, s66, 43008
  s_add_u32 s66, s66, s85
  buffer_load_dwordx4 v4, s[16:19], s66 offen offset:0 sc1 lds
  s_add_i32 s66, s72, 1
  s_max_i32 s66, s66, 0
  s_mul_i32 s66, s66, 43008
  s_add_u32 s66, s66, s85
  s_sub_u32 s66, s66, 1024
  buffer_load_dwordx4 v4, s[16:19], s66 offen offset:1024 sc1 lds
  s_add_i32 s66, s72, 2
  s_max_i32 s66, s66, 0
  s_mul_i32 s66, s66, 43008
  s_add_u32 s66, s66, s85
  s_sub_u32 s66, s66, 2048
  buffer_load_dwordx4 v4, s[16:19], s66 offen offset:2048 sc1 lds
  s_mul_i32 s63, s53, 6144
  s_add_u32 m0, s63, 44032
  s_add_i32 s66, s72, 3
  s_max_i32 s66, s66, 0
  s_mul_i32 s66, s66, 43008
  s_add_u32 s66, s66, s85
  buffer_load_dwordx4 v4, s[16:19], s66 offen offset:0 sc1 lds
  s_add_i32 s66, s72, 4
  s_max_i32 s66, s66, 0
  s_mul_i32 s66, s66, 43008
  s_add_u32 s66, s66, s85
  s_sub_u32 s66, s66, 1024
  buffer_load_dwordx4 v4, s[16:19], s66 offen offset:1024 sc1 lds
  s_add_i32 s66, s72, 5
  s_max_i32 s66, s66, 0
  s_mul_i32 s66, s66, 43008
  s_add_u32 s66, s66, s85
  s_sub_u32 s66, s66, 2048
  buffer_load_dwordx4 v4, s[16:19], s66 offen offset:2048 sc1 lds
  s_mul_i32 s63, s53, 6144
  s_add_u32 m0, s63, 16384
  s_add_i32 s66, s72, 0
  s_max_i32 s66, s66, 0
  s_mul_i32 s66, s66, 43008
  s_add_u32 s66, s66, s85
  buffer_load_dwordx4 v21, s[16:19], s66 offen offset:0 sc1 lds
  s_add_i32 s66, s72, 1
  s_max_i32 s66, s66, 0
  s_mul_i32 s66, s66, 43008
  s_add_u32 s66, s66, s85
  s_sub_u32 s66, s66, 1024
  buffer_load_dwordx4 v21, s[16:19], s66 offen offset:1024 sc1 lds
  s_add_i32 s66, s72, 2
  s_max_i32 s66, s66, 0
  s_mul_i32 s66, s66, 43008
  s_add_u32 s66, s66, s85
  s_sub_u32 s66, s66, 2048
  buffer_load_dwordx4 v21, s[16:19], s66 offen offset:2048 sc1 lds
  s_mul_i32 s63, s53, 6144
  s_add_u32 m0, s63, 19456
  s_add_i32 s66, s72, 3
  s_max_i32 s66, s66, 0
  s_mul_i32 s66, s66, 43008
  s_add_u32 s66, s66, s85
  buffer_load_dwordx4 v21, s[16:19], s66 offen offset:0 sc1 lds
  s_add_i32 s66, s72, 4
  s_max_i32 s66, s66, 0
  s_mul_i32 s66, s66, 43008
  s_add_u32 s66, s66, s85
  s_sub_u32 s66, s66, 1024
  buffer_load_dwordx4 v21, s[16:19], s66 offen offset:1024 sc1 lds
  s_add_i32 s66, s72, 5
  s_max_i32 s66, s66, 0
  s_mul_i32 s66, s66, 43008
  s_add_u32 s66, s66, s85
  s_sub_u32 s66, s66, 2048
  buffer_load_dwordx4 v21, s[16:19], s66 offen offset:2048 sc1 lds
L_sp1:
  s_barrier
  buffer_load_dwordx4 v[120:123], v4, s[16:19], s101 offen sc1
  s_waitcnt vmcnt(0) lgkmcnt(0)
L_att:
  v_mov_b32 v10, 0xf149f2ca
  v_lshlrev_b32 v8, 2, v3
  v_sub_u32 v8, v2, v8
  v_cmp_gt_i32 vcc, 0, v8
  s_nop 1
  v_cndmask_b32 v52, v10, 0, vcc
  v_sub_f32 v56, v10, v52
  v_cmp_gt_i32 vcc, 1, v8
  s_nop 1
  v_cndmask_b32 v53, v10, 0, vcc
  v_sub_f32 v57, v10, v53
  v_cmp_gt_i32 vcc, 2, v8
  s_nop 1
  v_cndmask_b32 v54, v10, 0, vcc
  v_sub_f32 v58, v10, v54
  v_cmp_gt_i32 vcc, 3, v8
  s_nop 1
  v_cndmask_b32 v55, v10, 0, vcc
  v_sub_f32 v59, v10, v55
  v_and_b32 v8, 3, v1
  v_add_u32 v8, s79, v8
  v_and_b32 v8, 4, v8
  v_lshlrev_b32 v8, 8, v8
  v_sub_u32 v28, v23, v8
  v_add_u32 v28, 512, v28
  s_sub_u32 s59, 1, s79
  s_cmp_eq_u32 s54, 0
  s_cbranch_scc1 L_nopatch
  s_mul_i32 s61, s59, 904
  v_lshlrev_b32 v60, 4, v2
  v_xor_b32 v60, s61, v60
  s_mul_i32 s62, s53, 6144
  s_add_u32 s62, s62, 16384
  v_add_u32 v60, s62, v60
  v_min_u32 v8, 2, v3
  v_lshl_add_u32 v60, v8, 10, v60
  v_add_u32 v8, s72, v8
  v_mov_b32 v9, 0x3f80
  v_cmp_le_i32 vcc, 0, v8
  v_mov_b32 v63, 0
  v_mov_b32 v69, 0
  v_cndmask_b32 v62, 0, v9, vcc
  v_cmp_le_i32 vcc, -3, v8
  s_nop 1
  v_cndmask_b32 v68, 0, v9, vcc
  s_waitcnt vmcnt(0)
  s_cmp_ge_i32 s72, 0
  s_cbranch_scc1 L_vz
  v_mov_b32 v64, 0
  v_mov_b32 v65, 0
  v_mov_b32 v66, 0
  v_mov_b32 v67, 0
  v_add_u32 v8, s62, v4
  ds_write_b128 v8, v[64:67] offset:0
  s_cmp_ge_i32 s72, -1
  s_cbranch_scc1 L_vz
  ds_write_b128 v8, v[64:67] offset:1024
  s_cmp_ge_i32 s72, -2
  s_cbranch_scc1 L_vz
  ds_write_b128 v8, v[64:67] offset:2048
  s_cmp_ge_i32 s72, -3
  s_cbranch_scc1 L_vz
  ds_write_b128 v8, v[64:67] offset:3072
  s_cmp_ge_i32 s72, -4
  s_cbranch_scc1 L_vz
  ds_write_b128 v8, v[64:67] offset:4096
  s_cmp_ge_i32 s72, -5
  s_cbranch_scc1 L_vz
  ds_write_b128 v8, v[64:67] offset:5120
L_vz:
  ds_write_b64 v60, v[62:63]
  ds_write_b64 v60, v[68:69] offset:3072
  s_branch L_patched
L_nopatch:
  s_waitcnt vmcnt(6)
L_patched:
  s_lshl_b32 s59, s59, 2
  s_add_u32 s60, s79, 3
  v_cmp_eq_u32 vcc, s59, v3
  v_cmp_eq_u32 s[60:61], s60, v3
  s_nop 0
  v_cndmask_b32 v48, v120, 0, vcc
  v_cndmask_b32 v49, v121, 0, vcc
  v_cndmask_b32 v50, v122, 0, s[60:61]
  v_cndmask_b32 v51, v123, 0, s[60:61]
  s_waitcnt lgkmcnt(0)
  s_barrier
  ds_read_b128 v[32:35], v22 offset:0
  ds_read_b128 v[36:39], v22 offset:1024
  ds_read_b128 v[40:43], v22 offset:2048
  ds_read_b128 v[44:47], v22 offset:3072
  ds_read_b64_tr_b16 v[64:65], v23 offset:0
  ds_read_b64_tr_b16 v[66:67], v23 offset:1024
  ds_read_b64_tr_b16 v[68:69], v28 offset:0
  ds_read_b64_tr_b16 v[70:71], v28 offset:1024
  ds_read_b64_tr_b16 v[72:73], v23 offset:2048
  ds_read_b64_tr_b16 v[74:75], v23 offset:3072
  ds_read_b64_tr_b16 v[76:77], v28 offset:2048
  ds_read_b64_tr_b16 v[78:79], v28 offset:3072
  s_mul_i32 s59, s52, 7
  s_lshr_b32 s59, s59, 2
  s_min_u32 s59, s59, 11
  s_lshl4_add_u32 s59, s81, s59
  s_lshl_b32 s59, s59, 7
  s_add_u32 s59, s59, 262144
  v_min_u32 v9, 5, v2
  v_lshl_add_u32 v5, v9, 6, s59
  s_mul_i32 s59, s81, 294912
  s_mul_i32 s60, s52, 7168
  s_add_u32 s68, s59, s60
  s_add_u32 s69, s68, 73728
  s_add_u32 s70, s68, 147456
  s_add_u32 s71, s68, 221184
  s_waitcnt lgkmcnt(11)
  v_mfma_f32_16x16x32_bf16 v[80:83], v[32:35], v[48:51], v[52:55]
  s_waitcnt lgkmcnt(10)
  v_mfma_f32_16x16x32_bf16 v[84:87], v[36:39], v[48:51], 0
  ds_read_b128 v[32:35], v22 offset:4096
  ds_read_b128 v[36:39], v22 offset:5120
  s_waitcnt lgkmcnt(11)
  v_mfma_f32_16x16x32_bf16 v[88:91], v[40:43], v[48:51], 0
  s_waitcnt lgkmcnt(10)
  v_mfma_f32_16x16x32_bf16 v[92:95], v[44:47], v[48:51], 0
  v_exp_f32 v80, v80
  ds_read_b64_tr_b16 v[160:161], v14 offset:0
  v_exp_f32 v81, v81
  ds_read_b64_tr_b16 v[162:163], v14 offset:512
  v_exp_f32 v82, v82
  ds_read_b64_tr_b16 v[164:165], v15 offset:0
  v_exp_f32 v83, v83
  ds_read_b64_tr_b16 v[166:167], v15 offset:512
  v_exp_f32 v84, v84
  ds_read_b64_tr_b16 v[168:169], v16 offset:0
  v_exp_f32 v85, v85
  ds_read_b64_tr_b16 v[170:171], v16 offset:512
  v_exp_f32 v86, v86
  ds_read_b64_tr_b16 v[172:173], v17 offset:0
  v_exp_f32 v87, v87
  ds_read_b64_tr_b16 v[174:175], v17 offset:512
  v_cvt_pk_bf16_f32 v80, v80, v81
  v_cvt_pk_bf16_f32 v81, v82, v83
  v_cvt_pk_bf16_f32 v82, v84, v85
  v_cvt_pk_bf16_f32 v83, v86, v87
  s_waitcnt lgkmcnt(14)
  s_nop 0
  v_mfma_f32_16x16x32_bf16 v[248:251], v[68:71], v[80:83], 0
  v_mfma_f32_16x16x32_bf16 v[244:247], v[64:67], v[80:83], 0
  ds_read_b64_tr_b16 v[64:65], v23 offset:4096
  ds_read_b64_tr_b16 v[66:67], v23 offset:5120
  ds_read_b64_tr_b16 v[68:69], v28 offset:4096
  ds_read_b64_tr_b16 v[70:71], v28 offset:5120
  ds_read_b128 v[40:43], v22 offset:6144
  ds_read_b128 v[44:47], v22 offset:7168
  s_waitcnt lgkmcnt(15)
  v_mfma_f32_16x16x32_bf16 v[96:99], v[32:35], v[48:51], 0
  s_waitcnt lgkmcnt(14)
  v_mfma_f32_16x16x32_bf16 v[100:103], v[36:39], v[48:51], 0
  v_exp_f32 v88, v88
  v_exp_f32 v89, v89
  s_add_u32 m0, s64, 114688
  s_add_u32 s66, s83, 86016
  buffer_load_dwordx4 v12, s[24:27], s66 offen lds
  v_exp_f32 v90, v90
  v_exp_f32 v91, v91
  buffer_load_dwordx4 v13, s[24:27], s66 offen offset:1024 lds
  v_exp_f32 v92, v92
  s_add_u32 m0, s64, 131072
  s_add_u32 s66, s83, 100352
  buffer_load_dwordx4 v12, s[24:27], s66 offen lds
  v_exp_f32 v93, v93
  v_exp_f32 v94, v94
  buffer_load_dwordx4 v13, s[24:27], s66 offen offset:1024 lds
  v_exp_f32 v95, v95
  v_cvt_pk_bf16_f32 v88, v88, v89
  v_cvt_pk_bf16_f32 v89, v90, v91
  v_cvt_pk_bf16_f32 v90, v92, v93
  v_cvt_pk_bf16_f32 v91, v94, v95
  s_nop 1
  v_mfma_f32_16x16x32_bf16 v[248:251], v[76:79], v[88:91], v[248:251]
  v_mfma_f32_16x16x32_bf16 v[244:247], v[72:75], v[88:91], v[244:247]
  ds_read_b64_tr_b16 v[72:73], v23 offset:6144
  ds_read_b64_tr_b16 v[74:75], v23 offset:7168
  ds_read_b64_tr_b16 v[76:77], v28 offset:6144
  ds_read_b64_tr_b16 v[78:79], v28 offset:7168
  ds_read_b128 v[32:35], v22 offset:8192
  ds_read_b128 v[36:39], v22 offset:9216
  s_waitcnt lgkmcnt(7)
  v_mfma_f32_16x16x32_bf16 v[80:83], v[40:43], v[48:51], 0
  s_waitcnt lgkmcnt(6)
  v_mfma_f32_16x16x32_bf16 v[84:87], v[44:47], v[48:51], 0
  s_waitcnt vmcnt(4)
  s_mul_i32 s59, s54, 28
  s_add_u32 s59, s59, s58
  s_cmp_ge_u32 s59, 28
  s_cbranch_scc1 L_nohp
  s_mov_b64 exec, 1
  buffer_store_dwordx2 v[6:7], off, s[44:47], s74 sc1
  s_mov_b64 exec, -1
L_nohp:
  v_exp_f32 v96, v96
  v_exp_f32 v97, v97
  v_exp_f32 v98, v98
  v_exp_f32 v99, v99
  v_exp_f32 v100, v100
  v_exp_f32 v101, v101
  v_exp_f32 v102, v102
  v_exp_f32 v103, v103
  v_cvt_pk_bf16_f32 v96, v96, v97
  v_cvt_pk_bf16_f32 v97, v98, v99
  v_cvt_pk_bf16_f32 v98, v100, v101
  v_cvt_pk_bf16_f32 v99, v102, v103
  s_nop 1
  v_mfma_f32_16x16x32_bf16 v[248:251], v[68:71], v[96:99], v[248:251]
  v_mfma_f32_16x16x32_bf16 v[244:247], v[64:67], v[96:99], v[244:247]
  ds_read_b64_tr_b16 v[64:65], v23 offset:8192
  ds_read_b64_tr_b16 v[66:67], v23 offset:9216
  ds_read_b64_tr_b16 v[68:69], v28 offset:8192
  ds_read_b64_tr_b16 v[70:71], v28 offset:9216
  ds_read_b128 v[40:43], v22 offset:10240
  ds_read_b128 v[44:47], v22 offset:11264
  s_waitcnt lgkmcnt(7)
  v_mfma_f32_16x16x32_bf16 v[88:91], v[32:35], v[48:51], 0
  s_waitcnt lgkmcnt(6)
  v_mfma_f32_16x16x32_bf16 v[92:95], v[36:39], v[48:51], 0
  v_exp_f32 v80, v80
  v_exp_f32 v81, v81
  v_exp_f32 v82, v82
  v_exp_f32 v83, v83
  v_exp_f32 v84, v84
  v_exp_f32 v85, v85
  v_exp_f32 v86, v86
  v_exp_f32 v87, v87
  v_cvt_pk_bf16_f32 v80, v80, v81
  v_cvt_pk_bf16_f32 v81, v82, v83
  v_cvt_pk_bf16_f32 v82, v84, v85
  v_cvt_pk_bf16_f32 v83, v86, v87
  s_nop 1
  v_mfma_f32_16x16x32_bf16 v[248:251], v[76:79], v[80:83], v[248:251]
  v_mfma_f32_16x16x32_bf16 v[244:247], v[72:75], v[80:83], v[244:247]
  ds_read_b64_tr_b16 v[72:73], v23 offset:10240
  ds_read_b64_tr_b16 v[74:75], v23 offset:11264
  ds_read_b64_tr_b16 v[76:77], v28 offset:10240
  ds_read_b64_tr_b16 v[78:79], v28 offset:11264
  ds_read_b128 v[32:35], v22 offset:12288
  ds_read_b128 v[36:39], v22 offset:13312
  s_waitcnt lgkmcnt(7)
  v_mfma_f32_16x16x32_bf16 v[96:99], v[40:43], v[48:51], 0
  s_waitcnt lgkmcnt(6)
  v_mfma_f32_16x16x32_bf16 v[100:103], v[44:47], v[48:51], 0
  v_exp_f32 v88, v88
  v_exp_f32 v89, v89
  s_add_u32 m0, s64, 81920
  s_add_u32 s66, s83, 114688
  buffer_load_dwordx4 v12, s[24:27], s66 offen lds
  v_exp_f32 v90, v90
  v_exp_f32 v91, v91
  buffer_load_dwordx4 v13, s[24:27], s66 offen offset:1024 lds
  v_exp_f32 v92, v92
  s_add_u32 m0, s64, 98304
  s_add_u32 s66, s83, 129024
  buffer_load_dwordx4 v12, s[24:27], s66 offen lds
  v_exp_f32 v93, v93
  v_exp_f32 v94, v94
  buffer_load_dwordx4 v13, s[24:27], s66 offen offset:1024 lds
  v_exp_f32 v95, v95
  v_cvt_pk_bf16_f32 v88, v88, v89
  v_cvt_pk_bf16_f32 v89, v90, v91
  v_cvt_pk_bf16_f32 v90, v92, v93
  v_cvt_pk_bf16_f32 v91, v94, v95
  s_nop 1
  v_mfma_f32_16x16x32_bf16 v[248:251], v[68:71], v[88:91], v[248:251]
  v_mfma_f32_16x16x32_bf16 v[244:247], v[64:67], v[88:91], v[244:247]
  ds_read_b64_tr_b16 v[64:65], v23 offset:12288
  ds_read_b64_tr_b16 v[66:67], v23 offset:13312
  ds_read_b64_tr_b16 v[68:69], v28 offset:12288
  ds_read_b64_tr_b16 v[70:71], v28 offset:13312
  ds_read_b128 v[40:43], v22 offset:14336
  ds_read_b128 v[44:47], v22 offset:15360
  s_waitcnt lgkmcnt(7)
  v_mfma_f32_16x16x32_bf16 v[80:83], v[32:35], v[48:51], 0
  s_waitcnt lgkmcnt(6)
  v_mfma_f32_16x16x32_bf16 v[84:87], v[36:39], v[48:51], 0
  v_exp_f32 v96, v96
  v_exp_f32 v97, v97
  v_exp_f32 v98, v98
  v_exp_f32 v99, v99
  v_exp_f32 v100, v100
  v_exp_f32 v101, v101
  v_exp_f32 v102, v102
  v_exp_f32 v103, v103
  v_cvt_pk_bf16_f32 v96, v96, v97
  v_cvt_pk_bf16_f32 v97, v98, v99
  v_cvt_pk_bf16_f32 v98, v100, v101
  v_cvt_pk_bf16_f32 v99, v102, v103
  s_nop 1
  v_mfma_f32_16x16x32_bf16 v[248:251], v[76:79], v[96:99], v[248:251]
  v_mfma_f32_16x16x32_bf16 v[244:247], v[72:75], v[96:99], v[244:247]
  ds_read_b64_tr_b16 v[72:73], v23 offset:14336
  ds_read_b64_tr_b16 v[74:75], v23 offset:15360
  ds_read_b64_tr_b16 v[76:77], v28 offset:14336
  ds_read_b64_tr_b16 v[78:79], v28 offset:15360
  ds_read_b128 v[32:35], v22 offset:16384
  s_waitcnt lgkmcnt(6)
  v_mfma_f32_16x16x32_bf16 v[88:91], v[40:43], v[48:51], 0
  s_waitcnt lgkmcnt(5)
  v_mfma_f32_16x16x32_bf16 v[92:95], v[44:47], v[48:51], 0
  v_exp_f32 v80, v80
  s_waitcnt vmcnt(4)
  ds_read_b64_tr_b16 v[176:177], v14 offset:32768
  v_exp_f32 v81, v81
  ds_read_b64_tr_b16 v[178:179], v14 offset:33280
  v_exp_f32 v82, v82
  ds_read_b64_tr_b16 v[180:181], v15 offset:32768
  v_exp_f32 v83, v83
  ds_read_b64_tr_b16 v[182:183], v15 offset:33280
  v_exp_f32 v84, v84
  ds_read_b64_tr_b16 v[184:185], v16 offset:32768
  v_exp_f32 v85, v85
  ds_read_b64_tr_b16 v[186:187], v16 offset:33280
  v_exp_f32 v86, v86
  ds_read_b64_tr_b16 v[188:189], v17 offset:32768
  v_exp_f32 v87, v87
  ds_read_b64_tr_b16 v[190:191], v17 offset:33280
  v_cvt_pk_bf16_f32 v80, v80, v81
  v_cvt_pk_bf16_f32 v81, v82, v83
  v_cvt_pk_bf16_f32 v82, v84, v85
  v_cvt_pk_bf16_f32 v83, v86, v87
  s_nop 1
  v_mfma_f32_16x16x32_bf16 v[248:251], v[68:71], v[80:83], v[248:251]
  v_mfma_f32_16x16x32_bf16 v[244:247], v[64:67], v[80:83], v[244:247]
  ds_read_b64_tr_b16 v[64:65], v23 offset:16384
  ds_read_b64_tr_b16 v[68:69], v28 offset:16384
  s_waitcnt lgkmcnt(10)
  v_mfma_f32_16x16x32_bf16 v[96:99], v[32:35], v[48:51], v[56:59]
  v_exp_f32 v88, v88
  s_waitcnt lgkmcnt(2)
  v_exp_f32 v89, v89
  s_add_u32 m0, s64, 114688
  s_add_u32 s66, s83, 143360
  buffer_load_dwordx4 v12, s[24:27], s66 offen lds
  v_exp_f32 v90, v90
  v_exp_f32 v91, v91
  buffer_load_dwordx4 v13, s[24:27], s66 offen offset:1024 lds
  v_exp_f32 v92, v92
  s_add_u32 m0, s64, 131072
  s_add_u32 s66, s83, 157696
  buffer_load_dwordx4 v12, s[24:27], s66 offen lds
  v_exp_f32 v93, v93
  v_exp_f32 v94, v94
  buffer_load_dwordx4 v13, s[24:27], s66 offen offset:1024 lds
  v_exp_f32 v95, v95
  v_cvt_pk_bf16_f32 v88, v88, v89
  v_cvt_pk_bf16_f32 v89, v90, v91
  v_cvt_pk_bf16_f32 v90, v92, v93
  v_cvt_pk_bf16_f32 v91, v94, v95
  s_nop 1
  v_mfma_f32_16x16x32_bf16 v[248:251], v[76:79], v[88:91], v[248:251]
  v_mfma_f32_16x16x32_bf16 v[244:247], v[72:75], v[88:91], v[244:247]
  v_exp_f32 v96, v96
  s_waitcnt vmcnt(4)
  ds_read_b64_tr_b16 v[192:193], v14 offset:0
  ds_read_b64_tr_b16 v[194:195], v14 offset:512
  v_exp_f32 v97, v97
  ds_read_b64_tr_b16 v[196:197], v15 offset:0
  ds_read_b64_tr_b16 v[198:199], v15 offset:512
  v_exp_f32 v98, v98
  ds_read_b64_tr_b16 v[200:201], v16 offset:0
  ds_read_b64_tr_b16 v[202:203], v16 offset:512
  v_exp_f32 v99, v99
  ds_read_b64_tr_b16 v[204:205], v17 offset:0
  ds_read_b64_tr_b16 v[206:207], v17 offset:512
  v_cvt_pk_bf16_f32 v96, v96, v97
  v_cvt_pk_bf16_f32 v97, v98, v99
  s_waitcnt lgkmcnt(8)
  s_nop 0
  v_mfma_f32_16x16x16_bf16 v[248:251], v[68:69], v[96:97], v[248:251]
  v_mfma_f32_16x16x16_bf16 v[244:247], v[64:65], v[96:97], v[244:247]
  buffer_load_dwordx2 v[30:31], v5, s[44:47], 0 offen sc1
  s_mov_b32 s36, 0
L_norm:
  v_cmp_eq_u32 s[60:61], 3, v3
  s_nop 3
  v_mov_b32 v8, v248
  v_mov_b32 v9, v248
  s_nop 1
  v_permlane32_swap_b32 v8, v9
  v_mov_b32 v8, v9
  s_nop 1
  v_permlane16_swap_b32 v8, v9
  v_cmp_nle_f32 vcc, 0x2b800000, v9
  s_nop 1
  s_mov_b64 s[62:63], vcc
  v_cmp_nge_f32 vcc, 0x5f800000, v9
  v_rcp_f32 v8, v9
  s_nop 0
  s_or_b64 vcc, vcc, s[62:63]
  s_cbranch_scc0 L_nofb
  s_cmp_eq_u32 s36, 0
  s_cbranch_scc1 L_fallback
L_nofb:
  v_cndmask_b32 v9, v8, 0, s[60:61]
  v_mul_f32 v244, v8, v244
  v_mul_f32 v245, v8, v245
  v_mul_f32 v246, v8, v246
  v_mul_f32 v247, v8, v247
  v_mul_f32 v248, v9, v248
  v_mul_f32 v249, v9, v249
  v_mul_f32 v250, v9, v250
  v_mul_f32 v251, v9, v251
  v_cvt_pk_bf16_f32 v244, v244, v245
  v_cvt_pk_bf16_f32 v245, v246, v247
  v_cvt_pk_bf16_f32 v246, v248, v249
  v_cvt_pk_bf16_f32 v247, v250, v251
  buffer_store_dwordx4 v[244:247], v4, s[28:31], s39 offen sc1
  s_cmp_lt_u32 s58, 28
  s_cbranch_scc1 L_d
  s_waitcnt vmcnt(0)
  s_mov_b64 exec, 1
  buffer_store_dwordx2 v[6:7], off, s[44:47], s75 sc1
  s_mov_b64 exec, -1
  s_branch L_fin
L_d:
  s_waitcnt lgkmcnt(0)
  s_add_u32 m0, s64, 81920
  s_add_u32 s66, s83, 172032
  buffer_load_dwordx4 v12, s[24:27], s66 offen lds
  buffer_load_dwordx4 v13, s[24:27], s66 offen offset:1024 lds
  s_add_u32 m0, s64, 98304
  s_add_u32 s66, s83, 186368
  buffer_load_dwordx4 v12, s[24:27], s66 offen lds
  buffer_load_dwordx4 v13, s[24:27], s66 offen offset:1024 lds
  s_waitcnt vmcnt(6)
  ds_read_b64_tr_b16 v[208:209], v14 offset:32768
  ds_read_b64_tr_b16 v[210:211], v14 offset:33280
  ds_read_b64_tr_b16 v[212:213], v15 offset:32768
  ds_read_b64_tr_b16 v[214:215], v15 offset:33280
  ds_read_b64_tr_b16 v[216:217], v16 offset:32768
  ds_read_b64_tr_b16 v[218:219], v16 offset:33280
  ds_read_b64_tr_b16 v[220:221], v17 offset:32768
  ds_read_b64_tr_b16 v[222:223], v17 offset:33280
  s_cmp_eq_u32 s54, 0
  s_cbranch_scc1 L_pr0
  s_setprio 1
L_pr0:
  v_readfirstlane_b32 s76, v6
  v_readfirstlane_b32 s77, v7
  s_waitcnt vmcnt(5)
  v_cmp_ne_u64 vcc, v[30:31], v[6:7]
  s_mov_b32 s38, 1
  s_nop 0
  s_cmp_eq_u64 vcc, 0
  s_cbranch_scc1 L_early
  s_mov_b32 s38, 0
  s_waitcnt vmcnt(0)
  s_mov_b64 exec, 1
  buffer_store_dwordx2 v[6:7], off, s[44:47], s75 sc1
  s_mov_b64 exec, -1
  s_mov_b32 s63, 0
Lpoll_9:
  buffer_load_dwordx2 v[30:31], v5, s[44:47], 0 offen sc1
  s_waitcnt vmcnt(0)
  v_cmp_ne_u64 vcc, v[30:31], v[6:7]
  s_add_u32 s63, s63, 1
  s_nop 0
  s_cmp_eq_u64 vcc, 0
  s_cbranch_scc1 Lok_10
  s_cmp_lt_u32 s63, 100000
  s_sleep 4
  s_cbranch_scc1 Lpoll_9
Lok_10:
L_early:
  buffer_load_dwordx4 v[104:107], v4, s[28:31], s68 offen offset:0 sc1
  buffer_load_dwordx4 v[108:111], v4, s[28:31], s69 offen offset:0 sc1
  buffer_load_dwordx4 v[112:115], v4, s[28:31], s70 offen offset:0 sc1
  buffer_load_dwordx4 v[116:119], v4, s[28:31], s68 offen offset:1024 sc1
  buffer_load_dwordx4 v[120:123], v4, s[28:31], s69 offen offset:1024 sc1
  buffer_load_dwordx4 v[124:127], v4, s[28:31], s70 offen offset:1024 sc1
  buffer_load_dwordx4 v[60:63], v4, s[28:31], s68 offen offset:2048 sc1
  s_waitcnt lgkmcnt(0)
  s_barrier
  v_add_u32 v21, 4096, v4
  s_waitcnt vmcnt(6)
  buffer_load_dwordx4 v[240:243], v4, s[28:31], s69 offen offset:2048 sc1
  v_mfma_f32_16x16x32_bf16 v[32:35], v[128:131], v[104:107], 0
  s_cmp_eq_u32 s38, 0
  s_cbranch_scc1 L_pubo
  s_mov_b64 exec, 1
  buffer_store_dwordx2 v[6:7], off, s[44:47], s75 sc1
  s_mov_b64 exec, -1
L_pubo:
  v_mfma_f32_16x16x32_bf16 v[36:39], v[132:135], v[104:107], 0
  s_add_u32 m0, s64, 114688
  s_add_u32 s66, s84, 0
  buffer_load_dwordx4 v18, s[48:51], s66 offen lds
  v_mfma_f32_16x16x32_bf16 v[40:43], v[136:139], v[104:107], 0
  buffer_load_dwordx4 v19, s[48:51], s66 offen offset:1024 lds
  v_mfma_f32_16x16x32_bf16 v[44:47], v[140:143], v[104:107], 0
  s_waitcnt vmcnt(8)
  buffer_load_dwordx4 v[104:107], v4, s[28:31], s70 offen offset:2048 sc1
  v_mfma_f32_16x16x32_bf16 v[64:67], v[128:131], v[108:111], 0
  s_add_u32 m0, s64, 131072
  s_add_u32 s66, s84, 7168
  buffer_load_dwordx4 v18, s[48:51], s66 offen lds
  v_mfma_f32_16x16x32_bf16 v[68:71], v[132:135], v[108:111], 0
  v_mfma_f32_16x16x32_bf16 v[72:75], v[136:139], v[108:111], 0
  v_mfma_f32_16x16x32_bf16 v[76:79], v[140:143], v[108:111], 0
  s_waitcnt vmcnt(9)
  buffer_load_dwordx4 v[108:111], v4, s[28:31], s68 offen offset:3072 sc1
  v_mfma_f32_16x16x32_bf16 v[48:51], v[128:131], v[112:115], 0
  buffer_load_dwordx4 v20, s[48:51], s66 offen offset:1024 lds
  v_mfma_f32_16x16x32_bf16 v[52:55], v[132:135], v[112:115], 0
  ds_read_b64_tr_b16 v[224:225], v14 offset:0
  v_mfma_f32_16x16x32_bf16 v[56:59], v[136:139], v[112:115], 0
  ds_read_b64_tr_b16 v[226:227], v14 offset:512
  ds_read_b64_tr_b16 v[228:229], v15 offset:0
  v_mfma_f32_16x16x32_bf16 v[252:255], v[140:143], v[112:115], 0
  ds_read_b64_tr_b16 v[230:231], v15 offset:512
  s_waitcnt vmcnt(10)
  buffer_load_dwordx4 v[112:115], v4, s[28:31], s69 offen offset:3072 sc1
  v_mfma_f32_16x16x32_bf16 v[32:35], v[144:147], v[116:119], v[32:35]
  ds_read_b64_tr_b16 v[232:233], v16 offset:0
  v_mfma_f32_16x16x32_bf16 v[36:39], v[148:151], v[116:119], v[36:39]
  ds_read_b64_tr_b16 v[234:235], v16 offset:512
  v_mfma_f32_16x16x32_bf16 v[40:43], v[152:155], v[116:119], v[40:43]
  ds_read_b64_tr_b16 v[236:237], v17 offset:0
  v_mfma_f32_16x16x32_bf16 v[44:47], v[156:159], v[116:119], v[44:47]
  ds_read_b64_tr_b16 v[238:239], v17 offset:512
  s_waitcnt vmcnt(10)
  buffer_load_dwordx4 v[116:119], v4, s[28:31], s70 offen offset:3072 sc1
  v_mfma_f32_16x16x32_bf16 v[64:67], v[144:147], v[120:123], v[64:67]
  v_mfma_f32_16x16x32_bf16 v[68:71], v[148:151], v[120:123], v[68:71]
  v_mfma_f32_16x16x32_bf16 v[72:75], v[152:155], v[120:123], v[72:75]
  v_mfma_f32_16x16x32_bf16 v[76:79], v[156:159], v[120:123], v[76:79]
  s_waitcnt vmcnt(10)
  buffer_load_dwordx4 v[120:123], v21, s[28:31], s68 offen offset:0 sc1
  v_mfma_f32_16x16x32_bf16 v[48:51], v[144:147], v[124:127], v[48:51]
  s_waitcnt lgkmcnt(0)
  v_mfma_f32_16x16x32_bf16 v[52:55], v[148:151], v[124:127], v[52:55]
  v_mfma_f32_16x16x32_bf16 v[56:59], v[152:155], v[124:127], v[56:59]
  s_add_u32 m0, s64, 81920
  s_add_u32 s66, s84, 25088
  buffer_load_dwordx4 v18, s[48:51], s66 offen lds
  v_mfma_f32_16x16x32_bf16 v[252:255], v[156:159], v[124:127], v[252:255]
  s_waitcnt vmcnt(11)
  buffer_load_dwordx4 v[124:127], v21, s[28:31], s69 offen offset:0 sc1
  v_mfma_f32_16x16x32_bf16 v[32:35], v[160:163], v[60:63], v[32:35]
  buffer_load_dwordx4 v19, s[48:51], s66 offen offset:1024 lds
  s_add_u32 m0, s64, 98304
  s_add_u32 s66, s84, 32256
  buffer_load_dwordx4 v18, s[48:51], s66 offen lds
  v_mfma_f32_16x16x32_bf16 v[36:39], v[164:167], v[60:63], v[36:39]
  s_mul_i32 s59, s52, 5120
  s_sub_u32 s59, 57344, s59
  v_mfma_f32_16x16x32_bf16 v[40:43], v[168:171], v[60:63], v[40:43]
  v_add_u32 v22, s59, v4
  s_lshl3_add_u32 s59, s81, s52
  v_mfma_f32_16x16x32_bf16 v[44:47], v[172:175], v[60:63], v[44:47]
  s_lshl_b32 s59, s59, 6
  s_waitcnt vmcnt(13)
  buffer_load_dwordx4 v[60:63], v21, s[28:31], s70 offen offset:0 sc1
  v_mfma_f32_16x16x32_bf16 v[64:67], v[160:163], v[240:243], v[64:67]
  buffer_load_dwordx4 v20, s[48:51], s66 offen offset:1024 lds
  s_add_u32 s62, s59, 524288
  v_mfma_f32_16x16x32_bf16 v[68:71], v[164:167], v[240:243], v[68:71]
  v_mul_u32_u24 v8, 896, v3
  v_mfma_f32_16x16x32_bf16 v[72:75], v[168:171], v[240:243], v[72:75]
  v_lshlrev_b32 v10, 3, v2
  v_add_u32 v28, v10, v8
  v_mfma_f32_16x16x32_bf16 v[76:79], v[172:175], v[240:243], v[76:79]
  s_lshl2_add_u32 s59, s81, s54
  s_waitcnt vmcnt(12)
  buffer_load_dwordx4 v[240:243], v21, s[28:31], s68 offen offset:1024 sc1
  v_mfma_f32_16x16x32_bf16 v[48:51], v[160:163], v[104:107], v[48:51]
  s_lshl2_add_u32 s59, s59, s53
  s_mul_i32 s59, s59, 3584
  v_mfma_f32_16x16x32_bf16 v[52:55], v[164:167], v[104:107], v[52:55]
  s_lshl_b32 s60, s82, 7
  v_mfma_f32_16x16x32_bf16 v[56:59], v[168:171], v[104:107], v[56:59]
  s_add_u32 s72, s59, s60
  v_mfma_f32_16x16x32_bf16 v[252:255], v[172:175], v[104:107], v[252:255]
  s_add_u32 s73, s72, 28672
  s_waitcnt vmcnt(11)
  buffer_load_dwordx4 v[104:107], v21, s[28:31], s69 offen offset:1024 sc1
  v_mfma_f32_16x16x32_bf16 v[32:35], v[176:179], v[108:111], v[32:35]
  s_load_dwordx16 s[8:23], s[44:45], s62 glc
  v_mfma_f32_16x16x32_bf16 v[36:39], v[180:183], v[108:111], v[36:39]
  v_mfma_f32_16x16x32_bf16 v[40:43], v[184:187], v[108:111], v[40:43]
  v_mfma_f32_16x16x32_bf16 v[44:47], v[188:191], v[108:111], v[44:47]
  s_waitcnt vmcnt(10)
  buffer_load_dwordx4 v[108:111], v21, s[28:31], s70 offen offset:1024 sc1
  v_mfma_f32_16x16x32_bf16 v[64:67], v[176:179], v[112:115], v[64:67]
  v_mfma_f32_16x16x32_bf16 v[68:71], v[180:183], v[112:115], v[68:71]
  v_mfma_f32_16x16x32_bf16 v[72:75], v[184:187], v[112:115], v[72:75]
  v_mfma_f32_16x16x32_bf16 v[76:79], v[188:191], v[112:115], v[76:79]
  s_waitcnt vmcnt(10)
  buffer_load_dwordx4 v[112:115], v21, s[28:31], s68 offen offset:2048 sc1
  v_mfma_f32_16x16x32_bf16 v[48:51], v[176:179], v[116:119], v[48:51]
  v_mfma_f32_16x16x32_bf16 v[52:55], v[180:183], v[116:119], v[52:55]
  v_mfma_f32_16x16x32_bf16 v[56:59], v[184:187], v[116:119], v[56:59]
  v_mfma_f32_16x16x32_bf16 v[252:255], v[188:191], v[116:119], v[252:255]
  s_waitcnt vmcnt(10)
  buffer_load_dwordx4 v[116:119], v21, s[28:31], s69 offen offset:2048 sc1
  v_mfma_f32_16x16x32_bf16 v[32:35], v[192:195], v[120:123], v[32:35]
  v_mfma_f32_16x16x32_bf16 v[36:39], v[196:199], v[120:123], v[36:39]
  v_mfma_f32_16x16x32_bf16 v[40:43], v[200:203], v[120:123], v[40:43]
  v_mfma_f32_16x16x32_bf16 v[44:47], v[204:207], v[120:123], v[44:47]
  s_waitcnt vmcnt(9)
  buffer_load_dwordx4 v[120:123], v21, s[28:31], s70 offen offset:2048 sc1
  v_mfma_f32_16x16x32_bf16 v[64:67], v[192:195], v[124:127], v[64:67]
  v_mfma_f32_16x16x32_bf16 v[68:71], v[196:199], v[124:127], v[68:71]
  v_mfma_f32_16x16x32_bf16 v[72:75], v[200:203], v[124:127], v[72:75]
  v_mfma_f32_16x16x32_bf16 v[76:79], v[204:207], v[124:127], v[76:79]
  s_waitcnt vmcnt(7)
  s_mov_b32 s63, 0
  s_branch Lpoc_12
Lpo_11:
  s_sleep 4
  s_load_dwordx16 s[8:23], s[44:45], s62 glc
Lpoc_12:
  s_waitcnt lgkmcnt(0)
  s_cmp_lg_u64 s[8:9], s[76:77]
  s_cbranch_scc1 Lpof_14
  s_cmp_lg_u64 s[10:11], s[76:77]
  s_cbranch_scc1 Lpof_14
  s_cmp_lg_u64 s[12:13], s[76:77]
  s_cbranch_scc1 Lpof_14
  s_cmp_lg_u64 s[14:15], s[76:77]
  s_cbranch_scc1 Lpof_14
  s_cmp_lg_u64 s[16:17], s[76:77]
  s_cbranch_scc1 Lpof_14
  s_cmp_lg_u64 s[18:19], s[76:77]
  s_cbranch_scc1 Lpof_14
  s_cmp_lg_u64 s[20:21], s[76:77]
  s_cbranch_scc1 Lpof_14
  s_cmp_lg_u64 s[22:23], s[76:77]
  s_cbranch_scc1 Lpof_14
  s_branch Lpoo_13
Lpof_14:
  s_add_u32 s63, s63, 1
  s_cmp_lt_u32 s63, 100000
  s_cbranch_scc1 Lpo_11
Lpoo_13:
  buffer_load_dwordx4 v[124:127], v22, s[28:31], s68 offen offset:0 sc1
  v_mfma_f32_16x16x32_bf16 v[48:51], v[192:195], v[60:63], v[48:51]
  ds_read_b64_tr_b16 v[80:81], v14 offset:32768
  v_mfma_f32_16x16x32_bf16 v[52:55], v[196:199], v[60:63], v[52:55]
  ds_read_b64_tr_b16 v[82:83], v14 offset:33280
  v_mfma_f32_16x16x32_bf16 v[56:59], v[200:203], v[60:63], v[56:59]
  ds_read_b64_tr_b16 v[84:85], v15 offset:32768
  v_mfma_f32_16x16x32_bf16 v[252:255], v[204:207], v[60:63], v[252:255]
  ds_read_b64_tr_b16 v[86:87], v15 offset:33280
  s_waitcnt vmcnt(6)
  buffer_load_dwordx4 v[60:63], v22, s[28:31], s68 offen offset:1024 sc1
  v_mfma_f32_16x16x32_bf16 v[32:35], v[208:211], v[240:243], v[32:35]
  ds_read_b64_tr_b16 v[88:89], v16 offset:32768
  v_mfma_f32_16x16x32_bf16 v[36:39], v[212:215], v[240:243], v[36:39]
  ds_read_b64_tr_b16 v[90:91], v16 offset:33280
  v_mfma_f32_16x16x32_bf16 v[40:43], v[216:219], v[240:243], v[40:43]
  ds_read_b64_tr_b16 v[92:93], v17 offset:32768
  v_mfma_f32_16x16x32_bf16 v[44:47], v[220:223], v[240:243], v[44:47]
  ds_read_b64_tr_b16 v[94:95], v17 offset:33280
  s_waitcnt vmcnt(6)
  buffer_load_dwordx4 v[240:243], v22, s[28:31], s69 offen offset:0 sc1
  v_mfma_f32_16x16x32_bf16 v[64:67], v[208:211], v[104:107], v[64:67]
  ds_read_b64_tr_b16 v[96:97], v14 offset:0
  v_mfma_f32_16x16x32_bf16 v[68:71], v[212:215], v[104:107], v[68:71]
  ds_read_b64_tr_b16 v[98:99], v14 offset:512
  v_mfma_f32_16x16x32_bf16 v[72:75], v[216:219], v[104:107], v[72:75]
  ds_read_b64_tr_b16 v[100:101], v15 offset:0
  v_mfma_f32_16x16x32_bf16 v[76:79], v[220:223], v[104:107], v[76:79]
  ds_read_b64_tr_b16 v[102:103], v15 offset:512
  s_waitcnt vmcnt(6)
  buffer_load_dwordx4 v[104:107], v22, s[28:31], s69 offen offset:1024 sc1
  v_mfma_f32_16x16x32_bf16 v[48:51], v[208:211], v[108:111], v[48:51]
  ds_read_b64_tr_b16 v[244:245], v16 offset:0
  ds_read_b64_tr_b16 v[246:247], v16 offset:512
  ds_read_b64_tr_b16 v[248:249], v17 offset:0
  v_mfma_f32_16x16x32_bf16 v[52:55], v[212:215], v[108:111], v[52:55]
  ds_read_b64_tr_b16 v[250:251], v17 offset:512
  buffer_load_dwordx2 v[24:25], v28, s[4:7], s72 offen
  v_mfma_f32_16x16x32_bf16 v[56:59], v[216:219], v[108:111], v[56:59]
  buffer_load_dwordx2 v[26:27], v28, s[4:7], s73 offen
  buffer_load_dwordx2 v[18:19], v10, s[40:43], s60 offen
  v_mfma_f32_16x16x32_bf16 v[252:255], v[220:223], v[108:111], v[252:255]
  s_mov_b32 s59, s65
  v_lshlrev_b32 v8, 4, v3
  s_waitcnt vmcnt(9)
  buffer_load_dwordx4 v[108:111], v22, s[28:31], s70 offen offset:0 sc1
  v_mfma_f32_16x16x32_bf16 v[32:35], v[224:227], v[112:115], v[32:35]
  s_setprio 0
  v_xor_b32 v8, v8, v4
  v_mfma_f32_16x16x32_bf16 v[36:39], v[228:231], v[112:115], v[36:39]
  v_add_u32 v29, s59, v8
  v_mfma_f32_16x16x32_bf16 v[40:43], v[232:235], v[112:115], v[40:43]
  s_lshl_b32 s59, s53, 2
  v_add_u32 v8, s59, v3
  v_mfma_f32_16x16x32_bf16 v[44:47], v[236:239], v[112:115], v[44:47]
  v_xor_b32 v8, v8, v2
  s_waitcnt vmcnt(9)
  buffer_load_dwordx4 v[112:115], v22, s[28:31], s70 offen offset:1024 sc1
  v_mfma_f32_16x16x32_bf16 v[64:67], v[224:227], v[116:119], v[64:67]
  v_lshlrev_b32 v8, 4, v8
  v_and_b32 v9, 3, v2
  v_mfma_f32_16x16x32_bf16 v[68:71], v[228:231], v[116:119], v[68:71]
  v_lshl_add_u32 v8, v9, 8, v8
  v_mfma_f32_16x16x32_bf16 v[72:75], v[232:235], v[116:119], v[72:75]
  v_lshrrev_b32 v9, 2, v2
  v_mfma_f32_16x16x32_bf16 v[76:79], v[236:239], v[116:119], v[76:79]
  v_lshl_add_u32 v8, v9, 13, v8
  s_waitcnt vmcnt(9)
  buffer_load_dwordx4 v[116:119], v4, s[28:31], s71 offen offset:0 sc1
  v_mfma_f32_16x16x32_bf16 v[48:51], v[224:227], v[120:123], v[48:51]
  s_lshl_b32 s59, s54, 15
  v_add_u32 v0, s59, v8
  v_mfma_f32_16x16x32_bf16 v[52:55], v[228:231], v[120:123], v[52:55]
  v_xor_b32 v30, 64, v29
  v_mfma_f32_16x16x32_bf16 v[56:59], v[232:235], v[120:123], v[56:59]
  v_xor_b32 v31, 128, v29
  v_mfma_f32_16x16x32_bf16 v[252:255], v[236:239], v[120:123], v[252:255]
  v_xor_b32 v20, 192, v29
  s_waitcnt vmcnt(9) lgkmcnt(8)
  buffer_load_dwordx4 v[120:123], v4, s[28:31], s71 offen offset:1024 sc1
  v_mfma_f32_16x16x32_bf16 v[32:35], v[80:83], v[124:127], v[32:35]
  v_mfma_f32_16x16x32_bf16 v[36:39], v[84:87], v[124:127], v[36:39]
  v_mfma_f32_16x16x32_bf16 v[40:43], v[88:91], v[124:127], v[40:43]
  v_mfma_f32_16x16x32_bf16 v[44:47], v[92:95], v[124:127], v[44:47]
  s_waitcnt vmcnt(9) lgkmcnt(0)
  buffer_load_dwordx4 v[124:127], v4, s[28:31], s71 offen offset:2048 sc1
  v_mfma_f32_16x16x32_bf16 v[32:35], v[96:99], v[60:63], v[32:35]
  v_mfma_f32_16x16x32_bf16 v[36:39], v[100:103], v[60:63], v[36:39]
  v_mfma_f32_16x16x32_bf16 v[40:43], v[244:247], v[60:63], v[40:43]
  v_mfma_f32_16x16x32_bf16 v[44:47], v[248:251], v[60:63], v[44:47]
  s_waitcnt vmcnt(9)
  buffer_load_dwordx4 v[60:63], v4, s[28:31], s71 offen offset:3072 sc1
  v_mfma_f32_16x16x32_bf16 v[64:67], v[80:83], v[240:243], v[64:67]
  s_nop 1
  ds_write_b128 v29, v[32:35] offset:0
  v_mfma_f32_16x16x32_bf16 v[68:71], v[84:87], v[240:243], v[68:71]
  v_mfma_f32_16x16x32_bf16 v[72:75], v[88:91], v[240:243], v[72:75]
  ds_write_b128 v30, v[36:39] offset:8192
  v_mfma_f32_16x16x32_bf16 v[76:79], v[92:95], v[240:243], v[76:79]
  s_waitcnt vmcnt(9)
  buffer_load_dwordx4 v[240:243], v21, s[28:31], s71 offen offset:0 sc1
  v_mfma_f32_16x16x32_bf16 v[64:67], v[96:99], v[104:107], v[64:67]
  ds_write_b128 v31, v[40:43] offset:16384
  v_mfma_f32_16x16x32_bf16 v[68:71], v[100:103], v[104:107], v[68:71]
  v_mfma_f32_16x16x32_bf16 v[72:75], v[244:247], v[104:107], v[72:75]
  ds_write_b128 v20, v[44:47] offset:24576
  v_mfma_f32_16x16x32_bf16 v[76:79], v[248:251], v[104:107], v[76:79]
  s_waitcnt vmcnt(6)
  buffer_load_dwordx4 v[104:107], v21, s[28:31], s71 offen offset:1024 sc1
  v_mfma_f32_16x16x32_bf16 v[48:51], v[80:83], v[108:111], v[48:51]
  v_lshlrev_b32 v12, 16, v24
  v_mfma_f32_16x16x32_bf16 v[52:55], v[84:87], v[108:111], v[52:55]
  v_and_b32 v13, 0xffff0000, v24
  v_lshlrev_b32 v8, 16, v18
  v_mfma_f32_16x16x32_bf16 v[56:59], v[88:91], v[108:111], v[56:59]
  v_and_b32 v9, 0xffff0000, v18
  ds_write_b128 v29, v[64:67] offset:32768
  v_mfma_f32_16x16x32_bf16 v[252:255], v[92:95], v[108:111], v[252:255]
  ds_write_b128 v30, v[68:71] offset:40960
  s_waitcnt vmcnt(6)
  buffer_load_dwordx4 v[108:111], v21, s[28:31], s71 offen offset:2048 sc1
  v_mfma_f32_16x16x32_bf16 v[48:51], v[96:99], v[112:115], v[48:51]
  v_add_f32 v12, v12, v8
  v_add_f32 v13, v13, v9
  v_mfma_f32_16x16x32_bf16 v[52:55], v[100:103], v[112:115], v[52:55]
  v_lshlrev_b32 v14, 16, v25
  v_mfma_f32_16x16x32_bf16 v[56:59], v[244:247], v[112:115], v[56:59]
  v_and_b32 v15, 0xffff0000, v25
  ds_write_b128 v31, v[72:75] offset:49152
  v_mfma_f32_16x16x32_bf16 v[252:255], v[248:251], v[112:115], v[252:255]
  ds_write_b128 v20, v[76:79] offset:57344
  s_waitcnt vmcnt(6) lgkmcnt(4)
  buffer_load_dwordx4 v[112:115], v22, s[28:31], s71 offen offset:0 sc1
  v_mfma_f32_16x16x32_bf16 v[32:35], v[128:131], v[116:119], 0
  v_lshlrev_b32 v8, 16, v19
  v_mfma_f32_16x16x32_bf16 v[36:39], v[132:135], v[116:119], 0
  v_and_b32 v9, 0xffff0000, v19
  v_mfma_f32_16x16x32_bf16 v[40:43], v[136:139], v[116:119], 0
  v_add_f32 v14, v14, v8
  v_mfma_f32_16x16x32_bf16 v[44:47], v[140:143], v[116:119], 0
  v_add_f32 v15, v15, v9
  s_waitcnt vmcnt(6)
  buffer_load_dwordx4 v[116:119], v22, s[28:31], s71 offen offset:1024 sc1
  v_mfma_f32_16x16x32_bf16 v[32:35], v[144:147], v[120:123], v[32:35]
  s_waitcnt lgkmcnt(0)
  s_barrier
  v_mfma_f32_16x16x32_bf16 v[36:39], v[148:151], v[120:123], v[36:39]
  v_mfma_f32_16x16x32_bf16 v[40:43], v[152:155], v[120:123], v[40:43]
  v_mfma_f32_16x16x32_bf16 v[44:47], v[156:159], v[120:123], v[44:47]
  s_waitcnt vmcnt(6)
  v_mfma_f32_16x16x32_bf16 v[32:35], v[160:163], v[124:127], v[32:35]
  v_add_u32 v29, 81920, v29
  v_mfma_f32_16x16x32_bf16 v[36:39], v[164:167], v[124:127], v[36:39]
  v_add_u32 v30, 81920, v30
  v_mfma_f32_16x16x32_bf16 v[40:43], v[168:171], v[124:127], v[40:43]
  v_add_u32 v31, 81920, v31
  v_mfma_f32_16x16x32_bf16 v[44:47], v[172:175], v[124:127], v[44:47]
  v_add_u32 v20, 81920, v20
  s_waitcnt vmcnt(5)
  v_mfma_f32_16x16x32_bf16 v[32:35], v[176:179], v[60:63], v[32:35]
  ds_write_b128 v29, v[48:51] offset:0
  ds_write_b128 v30, v[52:55] offset:8192
  ds_write_b128 v31, v[56:59] offset:16384
  ds_write_b128 v20, v[252:255] offset:24576
  v_mfma_f32_16x16x32_bf16 v[36:39], v[180:183], v[60:63], v[36:39]
  ds_read_b128 v[64:67], v0 offset:0
  ds_read_b128 v[68:71], v0 offset:1024
  ds_read_b128 v[72:75], v0 offset:2048
  ds_read_b128 v[76:79], v0 offset:3072
  v_mfma_f32_16x16x32_bf16 v[40:43], v[184:187], v[60:63], v[40:43]
  s_waitcnt lgkmcnt(3)
  v_add_f32 v12, v12, v64
  v_add_f32 v13, v13, v65
  v_add_f32 v14, v14, v66
  v_mfma_f32_16x16x32_bf16 v[44:47], v[188:191], v[60:63], v[44:47]
  v_add_f32 v15, v15, v67
  ds_read_b128 v[64:67], v0 offset:4096
  s_waitcnt lgkmcnt(3)
  s_waitcnt vmcnt(4)
  v_mfma_f32_16x16x32_bf16 v[32:35], v[192:195], v[240:243], v[32:35]
  v_add_f32 v12, v12, v68
  v_add_f32 v13, v13, v69
  v_add_f32 v14, v14, v70
  v_mfma_f32_16x16x32_bf16 v[36:39], v[196:199], v[240:243], v[36:39]
  v_add_f32 v15, v15, v71
  ds_read_b128 v[68:71], v0 offset:5120
  v_mfma_f32_16x16x32_bf16 v[40:43], v[200:203], v[240:243], v[40:43]
  s_waitcnt lgkmcnt(3)
  v_add_f32 v12, v12, v72
  v_add_f32 v13, v13, v73
  v_mfma_f32_16x16x32_bf16 v[44:47], v[204:207], v[240:243], v[44:47]
  v_add_f32 v14, v14, v74
  v_add_f32 v15, v15, v75
  s_waitcnt vmcnt(3)
  v_mfma_f32_16x16x32_bf16 v[32:35], v[208:211], v[104:107], v[32:35]
  ds_read_b128 v[72:75], v0 offset:6144
  s_waitcnt lgkmcnt(3)
  v_add_f32 v12, v12, v76
  v_mfma_f32_16x16x32_bf16 v[36:39], v[212:215], v[104:107], v[36:39]
  v_add_f32 v13, v13, v77
  v_add_f32 v14, v14, v78
  v_add_f32 v15, v15, v79
  v_mfma_f32_16x16x32_bf16 v[40:43], v[216:219], v[104:107], v[40:43]
  ds_read_b128 v[76:79], v0 offset:7168
  s_waitcnt lgkmcnt(3)
  v_add_f32 v12, v12, v64
  v_mfma_f32_16x16x32_bf16 v[44:47], v[220:223], v[104:107], v[44:47]
  v_add_f32 v13, v13, v65
  v_add_f32 v14, v14, v66
  s_waitcnt vmcnt(2)
  v_mfma_f32_16x16x32_bf16 v[32:35], v[224:227], v[108:111], v[32:35]
  v_add_f32 v15, v15, v67
  s_waitcnt lgkmcnt(2)
  v_add_f32 v12, v12, v68
  v_mfma_f32_16x16x32_bf16 v[36:39], v[228:231], v[108:111], v[36:39]
  v_add_f32 v13, v13, v69
  v_add_f32 v14, v14, v70
  v_mfma_f32_16x16x32_bf16 v[40:43], v[232:235], v[108:111], v[40:43]
  v_add_f32 v15, v15, v71
  s_waitcnt lgkmcnt(1)
  v_add_f32 v12, v12, v72
  v_mfma_f32_16x16x32_bf16 v[44:47], v[236:239], v[108:111], v[44:47]
  v_add_f32 v13, v13, v73
  v_add_f32 v14, v14, v74
  s_waitcnt vmcnt(1)
  v_mfma_f32_16x16x32_bf16 v[32:35], v[80:83], v[112:115], v[32:35]
  v_add_f32 v15, v15, v75
  s_waitcnt lgkmcnt(0)
  v_add_f32 v12, v12, v76
  v_mfma_f32_16x16x32_bf16 v[36:39], v[84:87], v[112:115], v[36:39]
  v_add_f32 v13, v13, v77
  v_add_f32 v14, v14, v78
  v_mfma_f32_16x16x32_bf16 v[40:43], v[88:91], v[112:115], v[40:43]
  v_add_f32 v15, v15, v79
  v_cvt_pk_bf16_f32 v8, v12, v13
  v_cvt_pk_bf16_f32 v9, v14, v15
  v_mfma_f32_16x16x32_bf16 v[44:47], v[92:95], v[112:115], v[44:47]
  buffer_store_dwordx2 v[8:9], v28, s[32:35], s72 offen sc1
  v_add_u32 v0, 81920, v0
  s_waitcnt vmcnt(1)
  v_mfma_f32_16x16x32_bf16 v[32:35], v[96:99], v[116:119], v[32:35]
  v_lshlrev_b32 v12, 16, v26
  v_and_b32 v13, 0xffff0000, v26
  v_lshlrev_b32 v8, 16, v18
  v_mfma_f32_16x16x32_bf16 v[36:39], v[100:103], v[116:119], v[36:39]
  v_and_b32 v9, 0xffff0000, v18
  v_add_f32 v12, v12, v8
  v_add_f32 v13, v13, v9
  v_mfma_f32_16x16x32_bf16 v[40:43], v[244:247], v[116:119], v[40:43]
  v_lshlrev_b32 v14, 16, v27
  v_and_b32 v15, 0xffff0000, v27
  v_lshlrev_b32 v8, 16, v19
  v_mfma_f32_16x16x32_bf16 v[44:47], v[248:251], v[116:119], v[44:47]
  v_and_b32 v9, 0xffff0000, v19
  v_add_f32 v14, v14, v8
  v_add_f32 v15, v15, v9
  ds_write_b128 v29, v[32:35] offset:32768
  ds_write_b128 v30, v[36:39] offset:40960
  ds_write_b128 v31, v[40:43] offset:49152
  s_nop 1
  ds_write_b128 v20, v[44:47] offset:57344
  s_waitcnt lgkmcnt(0)
  s_barrier
  ds_read_b128 v[128:131], v0 offset:0
  ds_read_b128 v[132:135], v0 offset:1024
  ds_read_b128 v[136:139], v0 offset:2048
  ds_read_b128 v[140:143], v0 offset:3072
  ds_read_b128 v[144:147], v0 offset:4096
  ds_read_b128 v[148:151], v0 offset:5120
  ds_read_b128 v[152:155], v0 offset:6144
  ds_read_b128 v[156:159], v0 offset:7168
  s_waitcnt lgkmcnt(7)
  v_add_f32 v12, v12, v128
  v_add_f32 v13, v13, v129
  v_add_f32 v14, v14, v130
  v_add_f32 v15, v15, v131
  s_waitcnt lgkmcnt(6)
  v_add_f32 v12, v12, v132
  v_add_f32 v13, v13, v133
  v_add_f32 v14, v14, v134
  v_add_f32 v15, v15, v135
  s_waitcnt lgkmcnt(5)
  v_add_f32 v12, v12, v136
  v_add_f32 v13, v13, v137
  v_add_f32 v14, v14, v138
  v_add_f32 v15, v15, v139
  s_waitcnt lgkmcnt(4)
  v_add_f32 v12, v12, v140
  v_add_f32 v13, v13, v141
  v_add_f32 v14, v14, v142
  v_add_f32 v15, v15, v143
  s_waitcnt lgkmcnt(3)
  v_add_f32 v12, v12, v144
  v_add_f32 v13, v13, v145
  v_add_f32 v14, v14, v146
  v_add_f32 v15, v15, v147
  s_waitcnt lgkmcnt(2)
  v_add_f32 v12, v12, v148
  v_add_f32 v13, v13, v149
  v_add_f32 v14, v14, v150
  v_add_f32 v15, v15, v151
  s_waitcnt lgkmcnt(1)
  v_add_f32 v12, v12, v152
  v_add_f32 v13, v13, v153
  v_add_f32 v14, v14, v154
  v_add_f32 v15, v15, v155
  s_waitcnt lgkmcnt(0)
  v_add_f32 v12, v12, v156
  v_add_f32 v13, v13, v157
  v_add_f32 v14, v14, v158
  v_add_f32 v15, v15, v159
  v_cvt_pk_bf16_f32 v8, v12, v13
  v_cvt_pk_bf16_f32 v9, v14, v15
  buffer_store_dwordx2 v[8:9], v28, s[32:35], s73 offen sc1
L_fin:
L_end:
  s_endpgm
L_fallback:
  s_waitcnt vmcnt(0) lgkmcnt(0)
  s_mov_b32 s36, 1
  s_mov_b32 s38, 0
  v_mov_b32 v10, 0xf149f2ca
  ds_read_b128 v[32:35], v22 offset:0
  ds_read_b128 v[36:39], v22 offset:1024
  ds_read_b128 v[40:43], v22 offset:2048
  ds_read_b128 v[44:47], v22 offset:3072
  s_waitcnt lgkmcnt(3)
  v_mfma_f32_16x16x32_bf16 v[60:63], v[32:35], v[48:51], v[52:55]
  ds_read_b128 v[32:35], v22 offset:4096
  s_waitcnt lgkmcnt(3)
  v_mfma_f32_16x16x32_bf16 v[64:67], v[36:39], v[48:51], 0
  ds_read_b128 v[36:39], v22 offset:5120
  s_waitcnt lgkmcnt(3)
  v_mfma_f32_16x16x32_bf16 v[68:71], v[40:43], v[48:51], 0
  ds_read_b128 v[40:43], v22 offset:6144
  s_waitcnt lgkmcnt(3)
  v_mfma_f32_16x16x32_bf16 v[72:75], v[44:47], v[48:51], 0
  ds_read_b128 v[44:47], v22 offset:7168
  s_waitcnt lgkmcnt(3)
  v_mfma_f32_16x16x32_bf16 v[76:79], v[32:35], v[48:51], 0
  ds_read_b128 v[32:35], v22 offset:8192
  s_waitcnt lgkmcnt(3)
  v_mfma_f32_16x16x32_bf16 v[80:83], v[36:39], v[48:51], 0
  ds_read_b128 v[36:39], v22 offset:9216
  s_waitcnt lgkmcnt(3)
  v_mfma_f32_16x16x32_bf16 v[84:87], v[40:43], v[48:51], 0
  ds_read_b128 v[40:43], v22 offset:10240
  s_waitcnt lgkmcnt(3)
  v_mfma_f32_16x16x32_bf16 v[88:91], v[44:47], v[48:51], 0
  ds_read_b128 v[44:47], v22 offset:11264
  s_waitcnt lgkmcnt(3)
  v_mfma_f32_16x16x32_bf16 v[92:95], v[32:35], v[48:51], 0
  ds_read_b128 v[32:35], v22 offset:12288
  s_waitcnt lgkmcnt(3)
  v_mfma_f32_16x16x32_bf16 v[96:99], v[36:39], v[48:51], 0
  ds_read_b128 v[36:39], v22 offset:13312
  s_waitcnt lgkmcnt(3)
  v_mfma_f32_16x16x32_bf16 v[100:103], v[40:43], v[48:51], 0
  ds_read_b128 v[40:43], v22 offset:14336
  s_waitcnt lgkmcnt(3)
  v_mfma_f32_16x16x32_bf16 v[104:107], v[44:47], v[48:51], 0
  ds_read_b128 v[44:47], v22 offset:15360
  s_waitcnt lgkmcnt(3)
  v_mfma_f32_16x16x32_bf16 v[108:111], v[32:35], v[48:51], 0
  ds_read_b128 v[32:35], v22 offset:16384
  s_waitcnt lgkmcnt(3)
  v_mfma_f32_16x16x32_bf16 v[112:115], v[36:39], v[48:51], 0
  s_waitcnt lgkmcnt(2)
  v_mfma_f32_16x16x32_bf16 v[116:119], v[40:43], v[48:51], 0
  s_waitcnt lgkmcnt(1)
  v_mfma_f32_16x16x32_bf16 v[120:123], v[44:47], v[48:51], 0
  s_waitcnt lgkmcnt(0)
  v_mfma_f32_16x16x32_bf16 v[124:127], v[32:35], v[48:51], v[56:59]
  ds_read_b64_tr_b16 v[32:33], v23 offset:0
  ds_read_b64_tr_b16 v[34:35], v23 offset:1024
  ds_read_b64_tr_b16 v[36:37], v28 offset:0
  ds_read_b64_tr_b16 v[38:39], v28 offset:1024
  ds_read_b64_tr_b16 v[40:41], v23 offset:2048
  ds_read_b64_tr_b16 v[42:43], v23 offset:3072
  ds_read_b64_tr_b16 v[44:45], v28 offset:2048
  ds_read_b64_tr_b16 v[46:47], v28 offset:3072
  s_nop 7
  s_cmp_le_i32 s80, 0
  s_cbranch_scc1 L_fixd
  v_mov_b32 v60, v10
  v_mov_b32 v61, v10
  v_mov_b32 v62, v10
  v_mov_b32 v63, v10
  s_cmp_le_i32 s80, 1
  s_cbranch_scc1 L_fixd
  v_mov_b32 v64, v10
  v_mov_b32 v65, v10
  v_mov_b32 v66, v10
  v_mov_b32 v67, v10
  s_cmp_le_i32 s80, 2
  s_cbranch_scc1 L_fixd
  v_mov_b32 v68, v10
  v_mov_b32 v69, v10
  v_mov_b32 v70, v10
  v_mov_b32 v71, v10
  s_cmp_le_i32 s80, 3
  s_cbranch_scc1 L_fixd
  v_mov_b32 v72, v10
  v_mov_b32 v73, v10
  v_mov_b32 v74, v10
  v_mov_b32 v75, v10
  s_cmp_le_i32 s80, 4
  s_cbranch_scc1 L_fixd
  v_mov_b32 v76, v10
  v_mov_b32 v77, v10
  v_mov_b32 v78, v10
  v_mov_b32 v79, v10
  s_cmp_le_i32 s80, 5
  s_cbranch_scc1 L_fixd
  v_mov_b32 v80, v10
  v_mov_b32 v81, v10
  v_mov_b32 v82, v10
  v_mov_b32 v83, v10
  s_cmp_le_i32 s80, 6
  s_cbranch_scc1 L_fixd
  v_mov_b32 v84, v10
  v_mov_b32 v85, v10
  v_mov_b32 v86, v10
  v_mov_b32 v87, v10
  s_cmp_le_i32 s80, 7
  s_cbranch_scc1 L_fixd
  v_mov_b32 v88, v10
  v_mov_b32 v89, v10
  v_mov_b32 v90, v10
  v_mov_b32 v91, v10
  s_cmp_le_i32 s80, 8
  s_cbranch_scc1 L_fixd
  v_mov_b32 v92, v10
  v_mov_b32 v93, v10
  v_mov_b32 v94, v10
  v_mov_b32 v95, v10
  s_cmp_le_i32 s80, 9
  s_cbranch_scc1 L_fixd
  v_mov_b32 v96, v10
  v_mov_b32 v97, v10
  v_mov_b32 v98, v10
  v_mov_b32 v99, v10
  s_cmp_le_i32 s80, 10
  s_cbranch_scc1 L_fixd
  v_mov_b32 v100, v10
  v_mov_b32 v101, v10
  v_mov_b32 v102, v10
  v_mov_b32 v103, v10
  s_cmp_le_i32 s80, 11
  s_cbranch_scc1 L_fixd
  v_mov_b32 v104, v10
  v_mov_b32 v105, v10
  v_mov_b32 v106, v10
  v_mov_b32 v107, v10
  s_cmp_le_i32 s80, 12
  s_cbranch_scc1 L_fixd
  v_mov_b32 v108, v10
  v_mov_b32 v109, v10
  v_mov_b32 v110, v10
  v_mov_b32 v111, v10
  s_cmp_le_i32 s80, 13
  s_cbranch_scc1 L_fixd
  v_mov_b32 v112, v10
  v_mov_b32 v113, v10
  v_mov_b32 v114, v10
  v_mov_b32 v115, v10
  s_cmp_le_i32 s80, 14
  s_cbranch_scc1 L_fixd
  v_mov_b32 v116, v10
  v_mov_b32 v117, v10
  v_mov_b32 v118, v10
  v_mov_b32 v119, v10
  s_cmp_le_i32 s80, 15
  s_cbranch_scc1 L_fixd
  v_mov_b32 v120, v10
  v_mov_b32 v121, v10
  v_mov_b32 v122, v10
  v_mov_b32 v123, v10
L_fixd:
  v_max_f32 v29, v60, v61
  v_max3_f32 v29, v29, v62, v63
  v_max3_f32 v29, v29, v64, v65
  v_max3_f32 v29, v29, v66, v67
  v_max3_f32 v29, v29, v68, v69
  v_max3_f32 v29, v29, v70, v71
  v_max3_f32 v29, v29, v72, v73
  v_max3_f32 v29, v29, v74, v75
  v_max3_f32 v29, v29, v76, v77
  v_max3_f32 v29, v29, v78, v79
  v_max3_f32 v29, v29, v80, v81
  v_max3_f32 v29, v29, v82, v83
  v_max3_f32 v29, v29, v84, v85
  v_max3_f32 v29, v29, v86, v87
  v_max3_f32 v29, v29, v88, v89
  v_max3_f32 v29, v29, v90, v91
  v_max3_f32 v29, v29, v92, v93
  v_max3_f32 v29, v29, v94, v95
  v_max3_f32 v29, v29, v96, v97
  v_max3_f32 v29, v29, v98, v99
  v_max3_f32 v29, v29, v100, v101
  v_max3_f32 v29, v29, v102, v103
  v_max3_f32 v29, v29, v104, v105
  v_max3_f32 v29, v29, v106, v107
  v_max3_f32 v29, v29, v108, v109
  v_max3_f32 v29, v29, v110, v111
  v_max3_f32 v29, v29, v112, v113
  v_max3_f32 v29, v29, v114, v115
  v_max3_f32 v29, v29, v116, v117
  v_max3_f32 v29, v29, v118, v119
  v_max3_f32 v29, v29, v120, v121
  v_max3_f32 v29, v29, v122, v123
  v_max3_f32 v29, v29, v124, v125
  v_max3_f32 v29, v29, v126, v127
  v_mov_b32 v8, v29
  s_nop 1
  v_permlane32_swap_b32 v29, v8
  v_max_f32 v29, v29, v8
  v_mov_b32 v8, v29
  s_nop 1
  v_permlane16_swap_b32 v29, v8
  v_max_f32 v29, v29, v8
  v_sub_f32 v60, v60, v29
  v_sub_f32 v61, v61, v29
  v_sub_f32 v62, v62, v29
  v_sub_f32 v63, v63, v29
  v_sub_f32 v64, v64, v29
  v_sub_f32 v65, v65, v29
  v_sub_f32 v66, v66, v29
  v_sub_f32 v67, v67, v29
  v_exp_f32 v60, v60
  v_exp_f32 v61, v61
  v_exp_f32 v62, v62
  v_exp_f32 v63, v63
  v_exp_f32 v64, v64
  v_exp_f32 v65, v65
  v_exp_f32 v66, v66
  v_exp_f32 v67, v67
  v_cvt_pk_bf16_f32 v60, v60, v61
  v_cvt_pk_bf16_f32 v61, v62, v63
  v_cvt_pk_bf16_f32 v62, v64, v65
  v_cvt_pk_bf16_f32 v63, v66, v67
  s_waitcnt lgkmcnt(4)
  s_nop 0
  v_mfma_f32_16x16x32_bf16 v[248:251], v[36:39], v[60:63], 0
  v_mfma_f32_16x16x32_bf16 v[244:247], v[32:35], v[60:63], 0
  ds_read_b64_tr_b16 v[32:33], v23 offset:4096
  ds_read_b64_tr_b16 v[34:35], v23 offset:5120
  ds_read_b64_tr_b16 v[36:37], v28 offset:4096
  ds_read_b64_tr_b16 v[38:39], v28 offset:5120
  v_sub_f32 v68, v68, v29
  v_sub_f32 v69, v69, v29
  v_sub_f32 v70, v70, v29
  v_sub_f32 v71, v71, v29
  v_sub_f32 v72, v72, v29
  v_sub_f32 v73, v73, v29
  v_sub_f32 v74, v74, v29
  v_sub_f32 v75, v75, v29
  v_exp_f32 v68, v68
  v_exp_f32 v69, v69
  v_exp_f32 v70, v70
  v_exp_f32 v71, v71
  v_exp_f32 v72, v72
  v_exp_f32 v73, v73
  v_exp_f32 v74, v74
  v_exp_f32 v75, v75
  v_cvt_pk_bf16_f32 v68, v68, v69
  v_cvt_pk_bf16_f32 v69, v70, v71
  v_cvt_pk_bf16_f32 v70, v72, v73
  v_cvt_pk_bf16_f32 v71, v74, v75
  s_waitcnt lgkmcnt(4)
  s_nop 0
  v_mfma_f32_16x16x32_bf16 v[248:251], v[44:47], v[68:71], v[248:251]
  v_mfma_f32_16x16x32_bf16 v[244:247], v[40:43], v[68:71], v[244:247]
  ds_read_b64_tr_b16 v[40:41], v23 offset:6144
  ds_read_b64_tr_b16 v[42:43], v23 offset:7168
  ds_read_b64_tr_b16 v[44:45], v28 offset:6144
  ds_read_b64_tr_b16 v[46:47], v28 offset:7168
  v_sub_f32 v76, v76, v29
  v_sub_f32 v77, v77, v29
  v_sub_f32 v78, v78, v29
  v_sub_f32 v79, v79, v29
  v_sub_f32 v80, v80, v29
  v_sub_f32 v81, v81, v29
  v_sub_f32 v82, v82, v29
  v_sub_f32 v83, v83, v29
  v_exp_f32 v76, v76
  v_exp_f32 v77, v77
  v_exp_f32 v78, v78
  v_exp_f32 v79, v79
  v_exp_f32 v80, v80
  v_exp_f32 v81, v81
  v_exp_f32 v82, v82
  v_exp_f32 v83, v83
  v_cvt_pk_bf16_f32 v76, v76, v77
  v_cvt_pk_bf16_f32 v77, v78, v79
  v_cvt_pk_bf16_f32 v78, v80, v81
  v_cvt_pk_bf16_f32 v79, v82, v83
  s_waitcnt lgkmcnt(4)
  s_nop 0
  v_mfma_f32_16x16x32_bf16 v[248:251], v[36:39], v[76:79], v[248:251]
  v_mfma_f32_16x16x32_bf16 v[244:247], v[32:35], v[76:79], v[244:247]
  ds_read_b64_tr_b16 v[32:33], v23 offset:8192
  ds_read_b64_tr_b16 v[34:35], v23 offset:9216
  ds_read_b64_tr_b16 v[36:37], v28 offset:8192
  ds_read_b64_tr_b16 v[38:39], v28 offset:9216
  v_sub_f32 v84, v84, v29
  v_sub_f32 v85, v85, v29
  v_sub_f32 v86, v86, v29
  v_sub_f32 v87, v87, v29
  v_sub_f32 v88, v88, v29
  v_sub_f32 v89, v89, v29
  v_sub_f32 v90, v90, v29
  v_sub_f32 v91, v91, v29
  v_exp_f32 v84, v84
  v_exp_f32 v85, v85
  v_exp_f32 v86, v86
  v_exp_f32 v87, v87
  v_exp_f32 v88, v88
  v_exp_f32 v89, v89
  v_exp_f32 v90, v90
  v_exp_f32 v91, v91
  v_cvt_pk_bf16_f32 v84, v84, v85
  v_cvt_pk_bf16_f32 v85, v86, v87
  v_cvt_pk_bf16_f32 v86, v88, v89
  v_cvt_pk_bf16_f32 v87, v90, v91
  s_waitcnt lgkmcnt(4)
  s_nop 0
  v_mfma_f32_16x16x32_bf16 v[248:251], v[44:47], v[84:87], v[248:251]
  v_mfma_f32_16x16x32_bf16 v[244:247], v[40:43], v[84:87], v[244:247]
  ds_read_b64_tr_b16 v[40:41], v23 offset:10240
  ds_read_b64_tr_b16 v[42:43], v23 offset:11264
  ds_read_b64_tr_b16 v[44:45], v28 offset:10240
  ds_read_b64_tr_b16 v[46:47], v28 offset:11264
  v_sub_f32 v92, v92, v29
  v_sub_f32 v93, v93, v29
  v_sub_f32 v94, v94, v29
  v_sub_f32 v95, v95, v29
  v_sub_f32 v96, v96, v29
  v_sub_f32 v97, v97, v29
  v_sub_f32 v98, v98, v29
  v_sub_f32 v99, v99, v29
  v_exp_f32 v92, v92
  v_exp_f32 v93, v93
  v_exp_f32 v94, v94
  v_exp_f32 v95, v95
  v_exp_f32 v96, v96
  v_exp_f32 v97, v97
  v_exp_f32 v98, v98
  v_exp_f32 v99, v99
  v_cvt_pk_bf16_f32 v92, v92, v93
  v_cvt_pk_bf16_f32 v93, v94, v95
  v_cvt_pk_bf16_f32 v94, v96, v97
  v_cvt_pk_bf16_f32 v95, v98, v99
  s_waitcnt lgkmcnt(4)
  s_nop 0
  v_mfma_f32_16x16x32_bf16 v[248:251], v[36:39], v[92:95], v[248:251]
  v_mfma_f32_16x16x32_bf16 v[244:247], v[32:35], v[92:95], v[244:247]
  ds_read_b64_tr_b16 v[32:33], v23 offset:12288
  ds_read_b64_tr_b16 v[34:35], v23 offset:13312
  ds_read_b64_tr_b16 v[36:37], v28 offset:12288
  ds_read_b64_tr_b16 v[38:39], v28 offset:13312
  v_sub_f32 v100, v100, v29
  v_sub_f32 v101, v101, v29
  v_sub_f32 v102, v102, v29
  v_sub_f32 v103, v103, v29
  v_sub_f32 v104, v104, v29
  v_sub_f32 v105, v105, v29
  v_sub_f32 v106, v106, v29
  v_sub_f32 v107, v107, v29
  v_exp_f32 v100, v100
  v_exp_f32 v101, v101
  v_exp_f32 v102, v102
  v_exp_f32 v103, v103
  v_exp_f32 v104, v104
  v_exp_f32 v105, v105
  v_exp_f32 v106, v106
  v_exp_f32 v107, v107
  v_cvt_pk_bf16_f32 v100, v100, v101
  v_cvt_pk_bf16_f32 v101, v102, v103
  v_cvt_pk_bf16_f32 v102, v104, v105
  v_cvt_pk_bf16_f32 v103, v106, v107
  s_waitcnt lgkmcnt(4)
  s_nop 0
  v_mfma_f32_16x16x32_bf16 v[248:251], v[44:47], v[100:103], v[248:251]
  v_mfma_f32_16x16x32_bf16 v[244:247], v[40:43], v[100:103], v[244:247]
  ds_read_b64_tr_b16 v[40:41], v23 offset:14336
  ds_read_b64_tr_b16 v[42:43], v23 offset:15360
  ds_read_b64_tr_b16 v[44:45], v28 offset:14336
  ds_read_b64_tr_b16 v[46:47], v28 offset:15360
  v_sub_f32 v108, v108, v29
  v_sub_f32 v109, v109, v29
  v_sub_f32 v110, v110, v29
  v_sub_f32 v111, v111, v29
  v_sub_f32 v112, v112, v29
  v_sub_f32 v113, v113, v29
  v_sub_f32 v114, v114, v29
  v_sub_f32 v115, v115, v29
  v_exp_f32 v108, v108
  v_exp_f32 v109, v109
  v_exp_f32 v110, v110
  v_exp_f32 v111, v111
  v_exp_f32 v112, v112
  v_exp_f32 v113, v113
  v_exp_f32 v114, v114
  v_exp_f32 v115, v115
  v_cvt_pk_bf16_f32 v108, v108, v109
  v_cvt_pk_bf16_f32 v109, v110, v111
  v_cvt_pk_bf16_f32 v110, v112, v113
  v_cvt_pk_bf16_f32 v111, v114, v115
  s_waitcnt lgkmcnt(4)
  s_nop 0
  v_mfma_f32_16x16x32_bf16 v[248:251], v[36:39], v[108:111], v[248:251]
  v_mfma_f32_16x16x32_bf16 v[244:247], v[32:35], v[108:111], v[244:247]
  ds_read_b64_tr_b16 v[32:33], v23 offset:16384
  ds_read_b64_tr_b16 v[36:37], v28 offset:16384
  v_sub_f32 v116, v116, v29
  v_sub_f32 v117, v117, v29
  v_sub_f32 v118, v118, v29
  v_sub_f32 v119, v119, v29
  v_sub_f32 v120, v120, v29
  v_sub_f32 v121, v121, v29
  v_sub_f32 v122, v122, v29
  v_sub_f32 v123, v123, v29
  v_exp_f32 v116, v116
  v_exp_f32 v117, v117
  v_exp_f32 v118, v118
  v_exp_f32 v119, v119
  v_exp_f32 v120, v120
  v_exp_f32 v121, v121
  v_exp_f32 v122, v122
  v_exp_f32 v123, v123
  v_cvt_pk_bf16_f32 v116, v116, v117
  v_cvt_pk_bf16_f32 v117, v118, v119
  v_cvt_pk_bf16_f32 v118, v120, v121
  v_cvt_pk_bf16_f32 v119, v122, v123
  s_waitcnt lgkmcnt(2)
  s_nop 0
  v_mfma_f32_16x16x32_bf16 v[248:251], v[44:47], v[116:119], v[248:251]
  v_mfma_f32_16x16x32_bf16 v[244:247], v[40:43], v[116:119], v[244:247]
  v_sub_f32 v124, v124, v29
  v_sub_f32 v125, v125, v29
  v_sub_f32 v126, v126, v29
  v_sub_f32 v127, v127, v29
  v_exp_f32 v124, v124
  v_exp_f32 v125, v125
  v_exp_f32 v126, v126
  v_exp_f32 v127, v127
  v_cvt_pk_bf16_f32 v124, v124, v125
  v_cvt_pk_bf16_f32 v125, v126, v127
  s_waitcnt lgkmcnt(0)
  s_nop 0
  v_mfma_f32_16x16x16_bf16 v[248:251], v[36:37], v[124:125], v[248:251]
  v_mfma_f32_16x16x16_bf16 v[244:247], v[32:33], v[124:125], v[244:247]
  s_nop 7
  s_branch L_norm
.section .rodata,"a"
.p2align 6
.amdhsa_kernel parallel_sum__sliding_block__dense_activation_squared_relu__prompt_kernel
  .amdhsa_next_free_vgpr 256
  .amdhsa_next_free_sgpr 102
  .amdhsa_accum_offset 256
  .amdhsa_group_segment_fixed_size 0
  .amdhsa_kernarg_size 88
  .amdhsa_user_sgpr_count 2
  .amdhsa_user_sgpr_kernarg_segment_ptr 1
  .amdhsa_system_sgpr_workgroup_id_x 1
.end_amdhsa_kernel
```
